```python
import torch

def _softmax(x, axis=-1):
    return torch.softmax(x, dim=axis)
def _gelu(x):
    return torch.nn.functional.gelu(x, approximate="tanh")
def _silu(x):
    return torch.nn.functional.silu(x)
def _sigmoid(x):
    return torch.sigmoid(x)
def _layernorm(x, axis=-1, eps=1e-5):
    m = x.mean(dim=axis, keepdim=True)
    v = x.var(dim=axis, keepdim=True, unbiased=False)
    return (x - m) / torch.sqrt(v + eps)
def _scatter_add(tgt, idx, src, axis=0):
    return tgt.clone().index_add_(axis, idx, src)
def _segment_sum(src, seg, n):
    out = torch.zeros((n,) + src.shape[1:], dtype=src.dtype)
    return out.index_add_(0, seg, src)
def _pad(x, pw):
    flat = tuple(v for pair in reversed(pw) for v in pair)
    return torch.nn.functional.pad(x, flat)

kernel_name = 'standalone__weight_only_int_quip_2__prompt'

def setup_inputs():

    _w = (lambda a: (lambda t: t.to(torch.bfloat16) if t.is_floating_point() else t)(torch.as_tensor(a)))
    B, S, D, F = 1, 2048, 576, 4608
    nbits = max(2, min(4, int(4)))
    G = 64 if 64 > 0 else D
    D = (D // G) * G
    ng = D // G
    qmax = 1 << nbits
    qw = torch.randint(0, qmax, (D, F)).to(torch.int32)
    zp = torch.randint(0, qmax, (ng, F)).to(float)
    sc = torch.abs((lambda *s: torch.randn(*s, dtype=torch.bfloat16) * 0.05)(ng, F)).to(float) * 0.1 + 0.02
    return {
        "x": _w((lambda *s: torch.randn(*s, dtype=torch.bfloat16) * 0.05)(B, S, D)),
        "qw": _w(qw),
        "scales": _w(sc),
        "zeros": _w(zp),
    }

def reference(x, qw, scales, zeros):
    B, S, D = x.shape
    ng, F = scales.shape
    G = D // ng
    s = (lambda x, n, axis: torch.repeat_interleave(x, n, dim=axis))(scales, G, axis=0)
    z = (lambda x, n, axis: torch.repeat_interleave(x, n, dim=axis))(zeros, G, axis=0)
    w = ((lambda x, dt: x.to(dt))(qw, x.dtype) - z) * s
    return torch.einsum("bsd,df->bsf", x, w)
```

```asm
; @launch grid=(256,1,1) block=(1024,1,1) lds=149728
.amdgcn_target "amdgcn-amd-amdhsa--gfx950"
.text
.globl standalone__weight_only_int_quip_2__prompt_kernel
.p2align 8
.type standalone__weight_only_int_quip_2__prompt_kernel,@function
standalone__weight_only_int_quip_2__prompt_kernel:
    s_cmp_ge_u32 s2, 256
    s_cbranch_scc1 L_done
    s_load_dwordx4 s[4:7], s[0:1], 0
    s_load_dwordx4 s[8:11], s[0:1], 16
    s_load_dwordx2 s[12:13], s[0:1], 32
    v_lshrrev_b32 v1, 6, v0
    s_and_b32 s14, s2, 7
    s_lshr_b32 s15, s2, 3
    v_readfirstlane_b32 s56, v1
    s_and_b32 s15, s15, 3
    s_lshl_b32 s14, s14, 2
    s_add_u32 s14, s14, s15
    s_lshr_b32 s57, s2, 5
    s_mul_i32 s54, s14, 576
    s_mul_i32 s55, s14, 288
    s_waitcnt lgkmcnt(0)
    s_mov_b32 s24, s6
    s_and_b32 s25, s7, 0xffff
    s_mov_b32 s26, 10616832
    s_mov_b32 s27, 0x00020000
    s_mov_b32 s28, s8
    s_and_b32 s29, s9, 0xffff
    s_mov_b32 s30, 82944
    s_mov_b32 s31, 0x00020000
    s_mov_b32 s32, s10
    s_and_b32 s33, s11, 0xffff
    s_mov_b32 s34, 82944
    s_mov_b32 s35, 0x00020000
    s_mov_b32 s20, s4
    s_and_b32 s21, s5, 0xffff
    s_mov_b32 s22, 2359296
    s_mov_b32 s23, 0x00020000
    s_mov_b32 s36, s12
    s_and_b32 s37, s13, 0xffff
    s_mov_b32 s38, 18874368
    s_mov_b32 s39, 0x00020000
    s_cmp_ge_u32 s56, 12
    s_cbranch_scc1 L_prod1
    s_cmp_ge_u32 s56, 8
    s_cbranch_scc1 L_prod0
    v_min_u32 v12, 323, v0
    v_mul_u32_u24 v13, 58255, v12
    v_lshrrev_b32 v13, 21, v13
    v_mul_u32_u24 v14, 36, v13
    v_sub_u32 v14, v12, v14
    v_mul_u32_u24 v13, 9216, v13
    v_lshl_add_u32 v13, v14, 3, v13
    v_add_u32 v13, s55, v13
    buffer_load_dwordx2 v[16:17], v13, s[28:31], 0 offen
    buffer_load_dwordx2 v[18:19], v13, s[32:35], 0 offen
    v_lshlrev_b32 v40, 4, v12
    v_add_u32 v40, 139264, v40
    s_lshl_b32 s58, s56, 13
    s_add_u32 s58, s58, 73728
    v_bfe_u32 v12, v0, 3, 3
    v_and_b32 v13, 7, v0
    v_xor_b32 v13, v13, v12
    s_lshl_b32 s16, s57, 3
    s_add_u32 s53, s16, s56
    s_mul_i32 s17, s53, 36864
    v_mul_u32_u24 v1, 1152, v12
    v_lshl_add_u32 v1, v13, 4, v1
    v_add_u32 v1, s17, v1
    s_add_u32 m0, s58, 0
    s_mov_b32 s59, 0
    buffer_load_dwordx4 v1, s[20:23], s59 offen lds
    s_add_u32 m0, s58, 1024
    s_mov_b32 s59, 9216
    buffer_load_dwordx4 v1, s[20:23], s59 offen lds
    s_add_u32 m0, s58, 2048
    s_mov_b32 s59, 18432
    buffer_load_dwordx4 v1, s[20:23], s59 offen lds
    s_add_u32 m0, s58, 3072
    s_mov_b32 s59, 27648
    buffer_load_dwordx4 v1, s[20:23], s59 offen lds
    s_add_u32 m0, s58, 4096
    s_mov_b32 s59, 128
    buffer_load_dwordx4 v1, s[20:23], s59 offen lds
    s_add_u32 m0, s58, 5120
    s_mov_b32 s59, 9344
    buffer_load_dwordx4 v1, s[20:23], s59 offen lds
    s_add_u32 m0, s58, 6144
    s_mov_b32 s59, 18560
    buffer_load_dwordx4 v1, s[20:23], s59 offen lds
    s_add_u32 m0, s58, 7168
    s_mov_b32 s59, 27776
    buffer_load_dwordx4 v1, s[20:23], s59 offen lds
    v_and_b32 v12, 15, v0
    v_bfe_u32 v13, v0, 4, 2
    v_and_b32 v14, 7, v12
    v_xor_b32 v14, v14, v13
    v_lshlrev_b32 v6, 7, v12
    v_lshl_add_u32 v6, v14, 4, v6
    v_add_u32 v6, s58, v6
    v_xor_b32 v7, 64, v6
    v_and_b32 v12, 63, v0
    v_lshlrev_b32 v2, 4, v12
    v_xor_b32 v4, 64, v2
    v_add_u32 v3, 65536, v2
    v_add_u32 v5, 65536, v4
    v_mov_b32 v8, 149632
    s_lshl_b32 s17, s56, 2
    s_add_u32 s17, s17, 149664
    v_mov_b32 v9, s17
    v_mov_b32 v10, 0
    ds_write_b32 v9, v10
    v_mov_b32 v56, 0
    v_mov_b32 v57, 0
    v_mov_b32 v58, 0
    v_mov_b32 v59, 0
    v_mov_b32 v60, 0
    v_mov_b32 v61, 0
    v_mov_b32 v62, 0
    v_mov_b32 v63, 0
    v_mov_b32 v64, 0
    v_mov_b32 v65, 0
    v_mov_b32 v66, 0
    v_mov_b32 v67, 0
    v_mov_b32 v68, 0
    v_mov_b32 v69, 0
    v_mov_b32 v70, 0
    v_mov_b32 v71, 0
    v_mov_b32 v72, 0
    v_mov_b32 v73, 0
    v_mov_b32 v74, 0
    v_mov_b32 v75, 0
    v_mov_b32 v76, 0
    v_mov_b32 v77, 0
    v_mov_b32 v78, 0
    v_mov_b32 v79, 0
    v_mov_b32 v80, 0
    v_mov_b32 v81, 0
    v_mov_b32 v82, 0
    v_mov_b32 v83, 0
    v_mov_b32 v84, 0
    v_mov_b32 v85, 0
    v_mov_b32 v86, 0
    v_mov_b32 v87, 0
    v_mov_b32 v88, 0
    v_mov_b32 v89, 0
    v_mov_b32 v90, 0
    v_mov_b32 v91, 0
    v_mov_b32 v92, 0
    v_mov_b32 v93, 0
    v_mov_b32 v94, 0
    v_mov_b32 v95, 0
    v_mov_b32 v96, 0
    v_mov_b32 v97, 0
    v_mov_b32 v98, 0
    v_mov_b32 v99, 0
    v_mov_b32 v100, 0
    v_mov_b32 v101, 0
    v_mov_b32 v102, 0
    v_mov_b32 v103, 0
    v_mov_b32 v104, 0
    v_mov_b32 v105, 0
    v_mov_b32 v106, 0
    v_mov_b32 v107, 0
    v_mov_b32 v108, 0
    v_mov_b32 v109, 0
    v_mov_b32 v110, 0
    v_mov_b32 v111, 0
    v_mov_b32 v112, 0
    v_mov_b32 v113, 0
    v_mov_b32 v114, 0
    v_mov_b32 v115, 0
    v_mov_b32 v116, 0
    v_mov_b32 v117, 0
    v_mov_b32 v118, 0
    v_mov_b32 v119, 0
    v_mov_b32 v120, 0
    v_mov_b32 v121, 0
    v_mov_b32 v122, 0
    v_mov_b32 v123, 0
    v_mov_b32 v124, 0
    v_mov_b32 v125, 0
    v_mov_b32 v126, 0
    v_mov_b32 v127, 0
    s_waitcnt vmcnt(8)
    v_mov_b32 v20, 0
    s_mov_b32 s16, 0x4b400000
    s_mov_b32 s17, 0x4b800000
    v_lshlrev_b32 v24, 16, v16
    v_and_b32 v25, 0xffff0000, v16
    v_lshlrev_b32 v26, 16, v17
    v_and_b32 v27, 0xffff0000, v17
    v_lshlrev_b32 v28, 16, v18
    v_and_b32 v29, 0xffff0000, v18
    v_lshlrev_b32 v30, 16, v19
    v_and_b32 v31, 0xffff0000, v19
    v_and_b32 v21, 0x7fffffff, v24
    v_subrev_u32 v21, 536870912, v21
    v_lshrrev_b32 v21, 23, v21
    v_add_f32 v22, s16, v28
    v_subrev_f32 v23, s16, v22
    v_xor_b32 v23, v23, v28
    v_subrev_u32 v22, s16, v22
    v_or3_b32 v20, v20, v22, v23
    v_or_b32 v20, v20, v21
    v_and_b32 v21, 0x7fffffff, v25
    v_subrev_u32 v21, 536870912, v21
    v_lshrrev_b32 v21, 23, v21
    v_add_f32 v22, s16, v29
    v_subrev_f32 v23, s16, v22
    v_xor_b32 v23, v23, v29
    v_subrev_u32 v22, s16, v22
    v_or3_b32 v20, v20, v22, v23
    v_or_b32 v20, v20, v21
    v_and_b32 v21, 0x7fffffff, v26
    v_subrev_u32 v21, 536870912, v21
    v_lshrrev_b32 v21, 23, v21
    v_add_f32 v22, s16, v30
    v_subrev_f32 v23, s16, v22
    v_xor_b32 v23, v23, v30
    v_subrev_u32 v22, s16, v22
    v_or3_b32 v20, v20, v22, v23
    v_or_b32 v20, v20, v21
    v_and_b32 v21, 0x7fffffff, v27
    v_subrev_u32 v21, 536870912, v21
    v_lshrrev_b32 v21, 23, v21
    v_add_f32 v22, s16, v31
    v_subrev_f32 v23, s16, v22
    v_xor_b32 v23, v23, v31
    v_subrev_u32 v22, s16, v22
    v_or3_b32 v20, v20, v22, v23
    v_or_b32 v20, v20, v21
    v_mul_f32 v36, v28, v24
    v_xor_b32 v36, 0x80000000, v36
    v_mul_f32 v32, s17, v24
    v_mul_f32 v37, v29, v25
    v_xor_b32 v37, 0x80000000, v37
    v_mul_f32 v33, s17, v25
    v_mul_f32 v38, v30, v26
    v_xor_b32 v38, 0x80000000, v38
    v_mul_f32 v34, s17, v26
    v_mul_f32 v39, v31, v27
    v_xor_b32 v39, 0x80000000, v39
    v_mul_f32 v35, s17, v27
    ds_write_b128 v40, v[32:35]
    ds_write_b128 v40, v[36:39] offset:5184
    v_and_b32 v20, 0xffffff80, v20
    v_cmp_ne_u32 vcc, 0, v20
    s_nop 1
    s_cmp_lg_u64 vcc, 0
    s_cselect_b32 s16, 1, 0
    v_mov_b32 v21, s16
    ds_write_b32 v9, v21 offset:32
    s_waitcnt lgkmcnt(0)
    s_barrier
    s_mov_b32 s60, 0
    s_mov_b32 s61, 0
    s_waitcnt vmcnt(4)
    ds_read_b128 v[16:19], v6 offset:0
    ds_read_b128 v[20:23], v6 offset:2048
    s_cmp_ge_u32 s60, 1
    s_cbranch_scc1 L_cok0
L_cw0:
    ds_read_b128 v[12:15], v8 offset:0
    s_waitcnt lgkmcnt(0)
    v_min_u32 v12, v12, v13
    v_min3_u32 v12, v12, v14, v15
    s_nop 0
    v_readfirstlane_b32 s60, v12
    s_nop 0
    s_cmp_ge_u32 s60, 1
    s_cbranch_scc1 L_cok0
    s_sleep 1
    s_branch L_cw0
L_cok0:
    ds_read_b128 v[32:35], v2 offset:0
    ds_read_b128 v[36:39], v2 offset:1024
    ds_read_b128 v[40:43], v2 offset:2048
    ds_read_b128 v[44:47], v2 offset:3072
    ds_read_b128 v[48:51], v4 offset:4096
    ds_read_b128 v[52:55], v4 offset:5120
    s_waitcnt lgkmcnt(6)
    s_waitcnt lgkmcnt(5)
    v_mfma_f32_16x16x32_bf16 v[56:59], v[16:19], v[32:35], v[56:59]
    v_mfma_f32_16x16x32_bf16 v[92:95], v[20:23], v[32:35], v[92:95]
    ds_read_b128 v[32:35], v4 offset:6144
    s_waitcnt lgkmcnt(5)
    v_mfma_f32_16x16x32_bf16 v[60:63], v[16:19], v[36:39], v[60:63]
    v_mfma_f32_16x16x32_bf16 v[96:99], v[20:23], v[36:39], v[96:99]
    ds_read_b128 v[36:39], v4 offset:7168
    s_waitcnt lgkmcnt(5)
    v_mfma_f32_16x16x32_bf16 v[64:67], v[16:19], v[40:43], v[64:67]
    v_mfma_f32_16x16x32_bf16 v[100:103], v[20:23], v[40:43], v[100:103]
    ds_read_b128 v[40:43], v2 offset:8192
    s_waitcnt lgkmcnt(5)
    v_mfma_f32_16x16x32_bf16 v[68:71], v[16:19], v[44:47], v[68:71]
    v_mfma_f32_16x16x32_bf16 v[104:107], v[20:23], v[44:47], v[104:107]
    ds_read_b128 v[44:47], v2 offset:9216
    ds_read_b128 v[24:27], v7 offset:0
    ds_read_b128 v[28:31], v7 offset:2048
    s_waitcnt lgkmcnt(7)
    v_mfma_f32_16x16x32_bf16 v[72:75], v[16:19], v[48:51], v[72:75]
    v_mfma_f32_16x16x32_bf16 v[108:111], v[20:23], v[48:51], v[108:111]
    ds_read_b128 v[48:51], v2 offset:10240
    s_waitcnt lgkmcnt(7)
    v_mfma_f32_16x16x32_bf16 v[76:79], v[16:19], v[52:55], v[76:79]
    v_mfma_f32_16x16x32_bf16 v[112:115], v[20:23], v[52:55], v[112:115]
    ds_read_b128 v[52:55], v2 offset:11264
    s_waitcnt lgkmcnt(7)
    v_mfma_f32_16x16x32_bf16 v[80:83], v[16:19], v[32:35], v[80:83]
    v_mfma_f32_16x16x32_bf16 v[116:119], v[20:23], v[32:35], v[116:119]
    ds_read_b128 v[32:35], v2 offset:12288
    s_waitcnt lgkmcnt(7)
    v_mfma_f32_16x16x32_bf16 v[84:87], v[16:19], v[36:39], v[84:87]
    v_mfma_f32_16x16x32_bf16 v[120:123], v[20:23], v[36:39], v[120:123]
    ds_read_b128 v[36:39], v4 offset:13312
    s_waitcnt lgkmcnt(7)
    v_mfma_f32_16x16x32_bf16 v[88:91], v[16:19], v[40:43], v[88:91]
    v_mfma_f32_16x16x32_bf16 v[124:127], v[20:23], v[40:43], v[124:127]
    ds_read_b128 v[40:43], v4 offset:14336
    s_waitcnt lgkmcnt(5)
    s_add_u32 m0, s58, 0
    s_mov_b32 s59, 256
    buffer_load_dwordx4 v1, s[20:23], s59 offen lds
    v_mfma_f32_16x16x32_bf16 v[56:59], v[24:27], v[44:47], v[56:59]
    v_mfma_f32_16x16x32_bf16 v[92:95], v[28:31], v[44:47], v[92:95]
    ds_read_b128 v[44:47], v4 offset:15360
    s_waitcnt lgkmcnt(5)
    v_mfma_f32_16x16x32_bf16 v[60:63], v[24:27], v[48:51], v[60:63]
    v_mfma_f32_16x16x32_bf16 v[96:99], v[28:31], v[48:51], v[96:99]
    ds_read_b128 v[48:51], v4 offset:16384
    s_add_u32 m0, s58, 1024
    s_mov_b32 s59, 9472
    buffer_load_dwordx4 v1, s[20:23], s59 offen lds
    s_waitcnt lgkmcnt(5)
    v_mfma_f32_16x16x32_bf16 v[64:67], v[24:27], v[52:55], v[64:67]
    v_mfma_f32_16x16x32_bf16 v[100:103], v[28:31], v[52:55], v[100:103]
    ds_read_b128 v[52:55], v2 offset:17408
    s_waitcnt lgkmcnt(5)
    v_mfma_f32_16x16x32_bf16 v[68:71], v[24:27], v[32:35], v[68:71]
    v_mfma_f32_16x16x32_bf16 v[104:107], v[28:31], v[32:35], v[104:107]
    s_waitcnt vmcnt(2)
    ds_read_b128 v[16:19], v6 offset:4096
    ds_read_b128 v[20:23], v6 offset:6144
    s_add_u32 m0, s58, 2048
    s_mov_b32 s59, 18688
    buffer_load_dwordx4 v1, s[20:23], s59 offen lds
    s_waitcnt lgkmcnt(6)
    v_mfma_f32_16x16x32_bf16 v[72:75], v[24:27], v[36:39], v[72:75]
    v_mfma_f32_16x16x32_bf16 v[108:111], v[28:31], v[36:39], v[108:111]
    s_cmp_ge_u32 s61, 2
    s_cbranch_scc1 L_cok1
L_cw1:
    ds_read_b128 v[12:15], v8 offset:16
    s_waitcnt lgkmcnt(0)
    v_min_u32 v12, v12, v13
    v_min3_u32 v12, v12, v14, v15
    s_nop 0
    v_readfirstlane_b32 s61, v12
    s_nop 0
    s_cmp_ge_u32 s61, 2
    s_cbranch_scc1 L_cok1
    s_sleep 1
    s_branch L_cw1
L_cok1:
    ds_read_b128 v[32:35], v2 offset:18432
    ds_read_b128 v[36:39], v2 offset:19456
    s_waitcnt lgkmcnt(7)
    v_mfma_f32_16x16x32_bf16 v[76:79], v[24:27], v[40:43], v[76:79]
    v_mfma_f32_16x16x32_bf16 v[112:115], v[28:31], v[40:43], v[112:115]
    ds_read_b128 v[40:43], v2 offset:20480
    s_add_u32 m0, s58, 3072
    s_mov_b32 s59, 27904
    buffer_load_dwordx4 v1, s[20:23], s59 offen lds
    s_waitcnt lgkmcnt(7)
    v_mfma_f32_16x16x32_bf16 v[80:83], v[24:27], v[44:47], v[80:83]
    v_mfma_f32_16x16x32_bf16 v[116:119], v[28:31], v[44:47], v[116:119]
    ds_read_b128 v[44:47], v2 offset:21504
    s_waitcnt lgkmcnt(7)
    v_mfma_f32_16x16x32_bf16 v[84:87], v[24:27], v[48:51], v[84:87]
    v_mfma_f32_16x16x32_bf16 v[120:123], v[28:31], v[48:51], v[120:123]
    ds_read_b128 v[48:51], v4 offset:22528
    s_waitcnt lgkmcnt(7)
    v_mov_b32 v10, 1
    s_mov_b64 exec, 1
    ds_write_b32 v9, v10
    s_mov_b64 exec, -1
    v_mfma_f32_16x16x32_bf16 v[88:91], v[24:27], v[52:55], v[88:91]
    v_mfma_f32_16x16x32_bf16 v[124:127], v[28:31], v[52:55], v[124:127]
    ds_read_b128 v[52:55], v4 offset:23552
    s_waitcnt lgkmcnt(7)
    s_waitcnt lgkmcnt(6)
    v_mfma_f32_16x16x32_bf16 v[56:59], v[16:19], v[32:35], v[56:59]
    v_mfma_f32_16x16x32_bf16 v[92:95], v[20:23], v[32:35], v[92:95]
    ds_read_b128 v[32:35], v4 offset:24576
    s_waitcnt lgkmcnt(6)
    v_mfma_f32_16x16x32_bf16 v[60:63], v[16:19], v[36:39], v[60:63]
    v_mfma_f32_16x16x32_bf16 v[96:99], v[20:23], v[36:39], v[96:99]
    ds_read_b128 v[36:39], v4 offset:25600
    s_waitcnt lgkmcnt(6)
    v_mfma_f32_16x16x32_bf16 v[64:67], v[16:19], v[40:43], v[64:67]
    v_mfma_f32_16x16x32_bf16 v[100:103], v[20:23], v[40:43], v[100:103]
    ds_read_b128 v[40:43], v2 offset:26624
    s_waitcnt lgkmcnt(6)
    v_mfma_f32_16x16x32_bf16 v[68:71], v[16:19], v[44:47], v[68:71]
    v_mfma_f32_16x16x32_bf16 v[104:107], v[20:23], v[44:47], v[104:107]
    ds_read_b128 v[44:47], v2 offset:27648
    ds_read_b128 v[24:27], v7 offset:4096
    ds_read_b128 v[28:31], v7 offset:6144
    s_waitcnt lgkmcnt(8)
    v_mfma_f32_16x16x32_bf16 v[72:75], v[16:19], v[48:51], v[72:75]
    v_mfma_f32_16x16x32_bf16 v[108:111], v[20:23], v[48:51], v[108:111]
    ds_read_b128 v[48:51], v2 offset:28672
    s_waitcnt lgkmcnt(7)
    v_mfma_f32_16x16x32_bf16 v[76:79], v[16:19], v[52:55], v[76:79]
    v_mfma_f32_16x16x32_bf16 v[112:115], v[20:23], v[52:55], v[112:115]
    ds_read_b128 v[52:55], v2 offset:29696
    s_waitcnt lgkmcnt(7)
    v_mfma_f32_16x16x32_bf16 v[80:83], v[16:19], v[32:35], v[80:83]
    v_mfma_f32_16x16x32_bf16 v[116:119], v[20:23], v[32:35], v[116:119]
    ds_read_b128 v[32:35], v2 offset:30720
    s_waitcnt lgkmcnt(7)
    v_mfma_f32_16x16x32_bf16 v[84:87], v[16:19], v[36:39], v[84:87]
    v_mfma_f32_16x16x32_bf16 v[120:123], v[20:23], v[36:39], v[120:123]
    ds_read_b128 v[36:39], v4 offset:31744
    s_waitcnt lgkmcnt(7)
    v_mfma_f32_16x16x32_bf16 v[88:91], v[16:19], v[40:43], v[88:91]
    v_mfma_f32_16x16x32_bf16 v[124:127], v[20:23], v[40:43], v[124:127]
    ds_read_b128 v[40:43], v4 offset:32768
    s_waitcnt lgkmcnt(5)
    s_add_u32 m0, s58, 4096
    s_mov_b32 s59, 384
    buffer_load_dwordx4 v1, s[20:23], s59 offen lds
    v_mfma_f32_16x16x32_bf16 v[56:59], v[24:27], v[44:47], v[56:59]
    v_mfma_f32_16x16x32_bf16 v[92:95], v[28:31], v[44:47], v[92:95]
    ds_read_b128 v[44:47], v4 offset:33792
    s_waitcnt lgkmcnt(5)
    v_mfma_f32_16x16x32_bf16 v[60:63], v[24:27], v[48:51], v[60:63]
    v_mfma_f32_16x16x32_bf16 v[96:99], v[28:31], v[48:51], v[96:99]
    ds_read_b128 v[48:51], v4 offset:34816
    s_add_u32 m0, s58, 5120
    s_mov_b32 s59, 9600
    buffer_load_dwordx4 v1, s[20:23], s59 offen lds
    s_waitcnt lgkmcnt(5)
    v_mfma_f32_16x16x32_bf16 v[64:67], v[24:27], v[52:55], v[64:67]
    v_mfma_f32_16x16x32_bf16 v[100:103], v[28:31], v[52:55], v[100:103]
    ds_read_b128 v[52:55], v2 offset:35840
    s_waitcnt lgkmcnt(5)
    v_mfma_f32_16x16x32_bf16 v[68:71], v[24:27], v[32:35], v[68:71]
    v_mfma_f32_16x16x32_bf16 v[104:107], v[28:31], v[32:35], v[104:107]
    s_waitcnt vmcnt(2)
    ds_read_b128 v[16:19], v6 offset:0
    ds_read_b128 v[20:23], v6 offset:2048
    s_add_u32 m0, s58, 6144
    s_mov_b32 s59, 18816
    buffer_load_dwordx4 v1, s[20:23], s59 offen lds
    s_waitcnt lgkmcnt(6)
    v_mfma_f32_16x16x32_bf16 v[72:75], v[24:27], v[36:39], v[72:75]
    v_mfma_f32_16x16x32_bf16 v[108:111], v[28:31], v[36:39], v[108:111]
    s_cmp_ge_u32 s60, 3
    s_cbranch_scc1 L_cok2
L_cw2:
    ds_read_b128 v[12:15], v8 offset:0
    s_waitcnt lgkmcnt(0)
    v_min_u32 v12, v12, v13
    v_min3_u32 v12, v12, v14, v15
    s_nop 0
    v_readfirstlane_b32 s60, v12
    s_nop 0
    s_cmp_ge_u32 s60, 3
    s_cbranch_scc1 L_cok2
    s_sleep 1
    s_branch L_cw2
L_cok2:
    ds_read_b128 v[32:35], v2 offset:36864
    ds_read_b128 v[36:39], v2 offset:37888
    s_waitcnt lgkmcnt(7)
    v_mfma_f32_16x16x32_bf16 v[76:79], v[24:27], v[40:43], v[76:79]
    v_mfma_f32_16x16x32_bf16 v[112:115], v[28:31], v[40:43], v[112:115]
    ds_read_b128 v[40:43], v2 offset:38912
    s_add_u32 m0, s58, 7168
    s_mov_b32 s59, 28032
    buffer_load_dwordx4 v1, s[20:23], s59 offen lds
    s_waitcnt lgkmcnt(7)
    v_mfma_f32_16x16x32_bf16 v[80:83], v[24:27], v[44:47], v[80:83]
    v_mfma_f32_16x16x32_bf16 v[116:119], v[28:31], v[44:47], v[116:119]
    ds_read_b128 v[44:47], v2 offset:39936
    s_waitcnt lgkmcnt(7)
    v_mfma_f32_16x16x32_bf16 v[84:87], v[24:27], v[48:51], v[84:87]
    v_mfma_f32_16x16x32_bf16 v[120:123], v[28:31], v[48:51], v[120:123]
    ds_read_b128 v[48:51], v4 offset:40960
    s_waitcnt lgkmcnt(7)
    v_mov_b32 v10, 2
    s_mov_b64 exec, 1
    ds_write_b32 v9, v10
    s_mov_b64 exec, -1
    v_mfma_f32_16x16x32_bf16 v[88:91], v[24:27], v[52:55], v[88:91]
    v_mfma_f32_16x16x32_bf16 v[124:127], v[28:31], v[52:55], v[124:127]
    ds_read_b128 v[52:55], v4 offset:41984
    s_waitcnt lgkmcnt(7)
    s_waitcnt lgkmcnt(6)
    v_mfma_f32_16x16x32_bf16 v[56:59], v[16:19], v[32:35], v[56:59]
    v_mfma_f32_16x16x32_bf16 v[92:95], v[20:23], v[32:35], v[92:95]
    ds_read_b128 v[32:35], v4 offset:43008
    s_waitcnt lgkmcnt(6)
    v_mfma_f32_16x16x32_bf16 v[60:63], v[16:19], v[36:39], v[60:63]
    v_mfma_f32_16x16x32_bf16 v[96:99], v[20:23], v[36:39], v[96:99]
    ds_read_b128 v[36:39], v4 offset:44032
    s_waitcnt lgkmcnt(6)
    v_mfma_f32_16x16x32_bf16 v[64:67], v[16:19], v[40:43], v[64:67]
    v_mfma_f32_16x16x32_bf16 v[100:103], v[20:23], v[40:43], v[100:103]
    ds_read_b128 v[40:43], v2 offset:45056
    s_waitcnt lgkmcnt(6)
    v_mfma_f32_16x16x32_bf16 v[68:71], v[16:19], v[44:47], v[68:71]
    v_mfma_f32_16x16x32_bf16 v[104:107], v[20:23], v[44:47], v[104:107]
    ds_read_b128 v[44:47], v2 offset:46080
    ds_read_b128 v[24:27], v7 offset:0
    ds_read_b128 v[28:31], v7 offset:2048
    s_waitcnt lgkmcnt(8)
    v_mfma_f32_16x16x32_bf16 v[72:75], v[16:19], v[48:51], v[72:75]
    v_mfma_f32_16x16x32_bf16 v[108:111], v[20:23], v[48:51], v[108:111]
    ds_read_b128 v[48:51], v2 offset:47104
    s_waitcnt lgkmcnt(7)
    v_mfma_f32_16x16x32_bf16 v[76:79], v[16:19], v[52:55], v[76:79]
    v_mfma_f32_16x16x32_bf16 v[112:115], v[20:23], v[52:55], v[112:115]
    ds_read_b128 v[52:55], v2 offset:48128
    s_waitcnt lgkmcnt(7)
    v_mfma_f32_16x16x32_bf16 v[80:83], v[16:19], v[32:35], v[80:83]
    v_mfma_f32_16x16x32_bf16 v[116:119], v[20:23], v[32:35], v[116:119]
    ds_read_b128 v[32:35], v2 offset:49152
    s_waitcnt lgkmcnt(7)
    v_mfma_f32_16x16x32_bf16 v[84:87], v[16:19], v[36:39], v[84:87]
    v_mfma_f32_16x16x32_bf16 v[120:123], v[20:23], v[36:39], v[120:123]
    ds_read_b128 v[36:39], v4 offset:50176
    s_waitcnt lgkmcnt(7)
    v_mfma_f32_16x16x32_bf16 v[88:91], v[16:19], v[40:43], v[88:91]
    v_mfma_f32_16x16x32_bf16 v[124:127], v[20:23], v[40:43], v[124:127]
    ds_read_b128 v[40:43], v4 offset:51200
    s_waitcnt lgkmcnt(5)
    s_add_u32 m0, s58, 0
    s_mov_b32 s59, 512
    buffer_load_dwordx4 v1, s[20:23], s59 offen lds
    v_mfma_f32_16x16x32_bf16 v[56:59], v[24:27], v[44:47], v[56:59]
    v_mfma_f32_16x16x32_bf16 v[92:95], v[28:31], v[44:47], v[92:95]
    ds_read_b128 v[44:47], v4 offset:52224
    s_waitcnt lgkmcnt(5)
    v_mfma_f32_16x16x32_bf16 v[60:63], v[24:27], v[48:51], v[60:63]
    v_mfma_f32_16x16x32_bf16 v[96:99], v[28:31], v[48:51], v[96:99]
    ds_read_b128 v[48:51], v4 offset:53248
    s_add_u32 m0, s58, 1024
    s_mov_b32 s59, 9728
    buffer_load_dwordx4 v1, s[20:23], s59 offen lds
    s_waitcnt lgkmcnt(5)
    v_mfma_f32_16x16x32_bf16 v[64:67], v[24:27], v[52:55], v[64:67]
    v_mfma_f32_16x16x32_bf16 v[100:103], v[28:31], v[52:55], v[100:103]
    ds_read_b128 v[52:55], v2 offset:54272
    s_waitcnt lgkmcnt(5)
    v_mfma_f32_16x16x32_bf16 v[68:71], v[24:27], v[32:35], v[68:71]
    v_mfma_f32_16x16x32_bf16 v[104:107], v[28:31], v[32:35], v[104:107]
    s_waitcnt vmcnt(2)
    ds_read_b128 v[16:19], v6 offset:4096
    ds_read_b128 v[20:23], v6 offset:6144
    s_add_u32 m0, s58, 2048
    s_mov_b32 s59, 18944
    buffer_load_dwordx4 v1, s[20:23], s59 offen lds
    s_waitcnt lgkmcnt(6)
    v_mfma_f32_16x16x32_bf16 v[72:75], v[24:27], v[36:39], v[72:75]
    v_mfma_f32_16x16x32_bf16 v[108:111], v[28:31], v[36:39], v[108:111]
    s_cmp_ge_u32 s61, 4
    s_cbranch_scc1 L_cok3
L_cw3:
    ds_read_b128 v[12:15], v8 offset:16
    s_waitcnt lgkmcnt(0)
    v_min_u32 v12, v12, v13
    v_min3_u32 v12, v12, v14, v15
    s_nop 0
    v_readfirstlane_b32 s61, v12
    s_nop 0
    s_cmp_ge_u32 s61, 4
    s_cbranch_scc1 L_cok3
    s_sleep 1
    s_branch L_cw3
L_cok3:
    ds_read_b128 v[32:35], v2 offset:55296
    ds_read_b128 v[36:39], v2 offset:56320
    s_waitcnt lgkmcnt(7)
    v_mfma_f32_16x16x32_bf16 v[76:79], v[24:27], v[40:43], v[76:79]
    v_mfma_f32_16x16x32_bf16 v[112:115], v[28:31], v[40:43], v[112:115]
    ds_read_b128 v[40:43], v2 offset:57344
    s_add_u32 m0, s58, 3072
    s_mov_b32 s59, 28160
    buffer_load_dwordx4 v1, s[20:23], s59 offen lds
    s_waitcnt lgkmcnt(7)
    v_mfma_f32_16x16x32_bf16 v[80:83], v[24:27], v[44:47], v[80:83]
    v_mfma_f32_16x16x32_bf16 v[116:119], v[28:31], v[44:47], v[116:119]
    ds_read_b128 v[44:47], v2 offset:58368
    s_waitcnt lgkmcnt(7)
    v_mfma_f32_16x16x32_bf16 v[84:87], v[24:27], v[48:51], v[84:87]
    v_mfma_f32_16x16x32_bf16 v[120:123], v[28:31], v[48:51], v[120:123]
    ds_read_b128 v[48:51], v4 offset:59392
    s_waitcnt lgkmcnt(7)
    v_mov_b32 v10, 3
    s_mov_b64 exec, 1
    ds_write_b32 v9, v10
    s_mov_b64 exec, -1
    v_mfma_f32_16x16x32_bf16 v[88:91], v[24:27], v[52:55], v[88:91]
    v_mfma_f32_16x16x32_bf16 v[124:127], v[28:31], v[52:55], v[124:127]
    ds_read_b128 v[52:55], v4 offset:60416
    s_waitcnt lgkmcnt(7)
    s_waitcnt lgkmcnt(6)
    v_mfma_f32_16x16x32_bf16 v[56:59], v[16:19], v[32:35], v[56:59]
    v_mfma_f32_16x16x32_bf16 v[92:95], v[20:23], v[32:35], v[92:95]
    ds_read_b128 v[32:35], v4 offset:61440
    s_waitcnt lgkmcnt(6)
    v_mfma_f32_16x16x32_bf16 v[60:63], v[16:19], v[36:39], v[60:63]
    v_mfma_f32_16x16x32_bf16 v[96:99], v[20:23], v[36:39], v[96:99]
    ds_read_b128 v[36:39], v4 offset:62464
    s_waitcnt lgkmcnt(6)
    v_mfma_f32_16x16x32_bf16 v[64:67], v[16:19], v[40:43], v[64:67]
    v_mfma_f32_16x16x32_bf16 v[100:103], v[20:23], v[40:43], v[100:103]
    ds_read_b128 v[40:43], v2 offset:63488
    s_waitcnt lgkmcnt(6)
    v_mfma_f32_16x16x32_bf16 v[68:71], v[16:19], v[44:47], v[68:71]
    v_mfma_f32_16x16x32_bf16 v[104:107], v[20:23], v[44:47], v[104:107]
    ds_read_b128 v[44:47], v2 offset:64512
    ds_read_b128 v[24:27], v7 offset:4096
    ds_read_b128 v[28:31], v7 offset:6144
    s_waitcnt lgkmcnt(8)
    v_mfma_f32_16x16x32_bf16 v[72:75], v[16:19], v[48:51], v[72:75]
    v_mfma_f32_16x16x32_bf16 v[108:111], v[20:23], v[48:51], v[108:111]
    ds_read_b128 v[48:51], v3 offset:0
    s_waitcnt lgkmcnt(7)
    v_mfma_f32_16x16x32_bf16 v[76:79], v[16:19], v[52:55], v[76:79]
    v_mfma_f32_16x16x32_bf16 v[112:115], v[20:23], v[52:55], v[112:115]
    ds_read_b128 v[52:55], v3 offset:1024
    s_waitcnt lgkmcnt(7)
    v_mfma_f32_16x16x32_bf16 v[80:83], v[16:19], v[32:35], v[80:83]
    v_mfma_f32_16x16x32_bf16 v[116:119], v[20:23], v[32:35], v[116:119]
    ds_read_b128 v[32:35], v3 offset:2048
    s_waitcnt lgkmcnt(7)
    v_mfma_f32_16x16x32_bf16 v[84:87], v[16:19], v[36:39], v[84:87]
    v_mfma_f32_16x16x32_bf16 v[120:123], v[20:23], v[36:39], v[120:123]
    ds_read_b128 v[36:39], v5 offset:3072
    s_waitcnt lgkmcnt(7)
    v_mfma_f32_16x16x32_bf16 v[88:91], v[16:19], v[40:43], v[88:91]
    v_mfma_f32_16x16x32_bf16 v[124:127], v[20:23], v[40:43], v[124:127]
    ds_read_b128 v[40:43], v5 offset:4096
    s_waitcnt lgkmcnt(5)
    s_add_u32 m0, s58, 4096
    s_mov_b32 s59, 640
    buffer_load_dwordx4 v1, s[20:23], s59 offen lds
    v_mfma_f32_16x16x32_bf16 v[56:59], v[24:27], v[44:47], v[56:59]
    v_mfma_f32_16x16x32_bf16 v[92:95], v[28:31], v[44:47], v[92:95]
    ds_read_b128 v[44:47], v5 offset:5120
    s_waitcnt lgkmcnt(5)
    v_mfma_f32_16x16x32_bf16 v[60:63], v[24:27], v[48:51], v[60:63]
    v_mfma_f32_16x16x32_bf16 v[96:99], v[28:31], v[48:51], v[96:99]
    ds_read_b128 v[48:51], v5 offset:6144
    s_add_u32 m0, s58, 5120
    s_mov_b32 s59, 9856
    buffer_load_dwordx4 v1, s[20:23], s59 offen lds
    s_waitcnt lgkmcnt(5)
    v_mfma_f32_16x16x32_bf16 v[64:67], v[24:27], v[52:55], v[64:67]
    v_mfma_f32_16x16x32_bf16 v[100:103], v[28:31], v[52:55], v[100:103]
    ds_read_b128 v[52:55], v3 offset:7168
    s_waitcnt lgkmcnt(5)
    v_mfma_f32_16x16x32_bf16 v[68:71], v[24:27], v[32:35], v[68:71]
    v_mfma_f32_16x16x32_bf16 v[104:107], v[28:31], v[32:35], v[104:107]
    s_waitcnt vmcnt(2)
    ds_read_b128 v[16:19], v6 offset:0
    ds_read_b128 v[20:23], v6 offset:2048
    s_add_u32 m0, s58, 6144
    s_mov_b32 s59, 19072
    buffer_load_dwordx4 v1, s[20:23], s59 offen lds
    s_waitcnt lgkmcnt(6)
    v_mfma_f32_16x16x32_bf16 v[72:75], v[24:27], v[36:39], v[72:75]
    v_mfma_f32_16x16x32_bf16 v[108:111], v[28:31], v[36:39], v[108:111]
    s_cmp_ge_u32 s60, 5
    s_cbranch_scc1 L_cok4
L_cw4:
    ds_read_b128 v[12:15], v8 offset:0
    s_waitcnt lgkmcnt(0)
    v_min_u32 v12, v12, v13
    v_min3_u32 v12, v12, v14, v15
    s_nop 0
    v_readfirstlane_b32 s60, v12
    s_nop 0
    s_cmp_ge_u32 s60, 5
    s_cbranch_scc1 L_cok4
    s_sleep 1
    s_branch L_cw4
L_cok4:
    ds_read_b128 v[32:35], v2 offset:0
    ds_read_b128 v[36:39], v2 offset:1024
    s_waitcnt lgkmcnt(7)
    v_mfma_f32_16x16x32_bf16 v[76:79], v[24:27], v[40:43], v[76:79]
    v_mfma_f32_16x16x32_bf16 v[112:115], v[28:31], v[40:43], v[112:115]
    ds_read_b128 v[40:43], v2 offset:2048
    s_add_u32 m0, s58, 7168
    s_mov_b32 s59, 28288
    buffer_load_dwordx4 v1, s[20:23], s59 offen lds
    s_waitcnt lgkmcnt(7)
    v_mfma_f32_16x16x32_bf16 v[80:83], v[24:27], v[44:47], v[80:83]
    v_mfma_f32_16x16x32_bf16 v[116:119], v[28:31], v[44:47], v[116:119]
    ds_read_b128 v[44:47], v2 offset:3072
    s_waitcnt lgkmcnt(7)
    v_mfma_f32_16x16x32_bf16 v[84:87], v[24:27], v[48:51], v[84:87]
    v_mfma_f32_16x16x32_bf16 v[120:123], v[28:31], v[48:51], v[120:123]
    ds_read_b128 v[48:51], v4 offset:4096
    s_waitcnt lgkmcnt(7)
    v_mov_b32 v10, 4
    s_mov_b64 exec, 1
    ds_write_b32 v9, v10
    s_mov_b64 exec, -1
    v_mfma_f32_16x16x32_bf16 v[88:91], v[24:27], v[52:55], v[88:91]
    v_mfma_f32_16x16x32_bf16 v[124:127], v[28:31], v[52:55], v[124:127]
    ds_read_b128 v[52:55], v4 offset:5120
    s_waitcnt lgkmcnt(7)
    s_waitcnt lgkmcnt(6)
    v_mfma_f32_16x16x32_bf16 v[56:59], v[16:19], v[32:35], v[56:59]
    v_mfma_f32_16x16x32_bf16 v[92:95], v[20:23], v[32:35], v[92:95]
    ds_read_b128 v[32:35], v4 offset:6144
    s_waitcnt lgkmcnt(6)
    v_mfma_f32_16x16x32_bf16 v[60:63], v[16:19], v[36:39], v[60:63]
    v_mfma_f32_16x16x32_bf16 v[96:99], v[20:23], v[36:39], v[96:99]
    ds_read_b128 v[36:39], v4 offset:7168
    s_waitcnt lgkmcnt(6)
    v_mfma_f32_16x16x32_bf16 v[64:67], v[16:19], v[40:43], v[64:67]
    v_mfma_f32_16x16x32_bf16 v[100:103], v[20:23], v[40:43], v[100:103]
    ds_read_b128 v[40:43], v2 offset:8192
    s_waitcnt lgkmcnt(6)
    v_mfma_f32_16x16x32_bf16 v[68:71], v[16:19], v[44:47], v[68:71]
    v_mfma_f32_16x16x32_bf16 v[104:107], v[20:23], v[44:47], v[104:107]
    ds_read_b128 v[44:47], v2 offset:9216
    ds_read_b128 v[24:27], v7 offset:0
    ds_read_b128 v[28:31], v7 offset:2048
    s_waitcnt lgkmcnt(8)
    v_mfma_f32_16x16x32_bf16 v[72:75], v[16:19], v[48:51], v[72:75]
    v_mfma_f32_16x16x32_bf16 v[108:111], v[20:23], v[48:51], v[108:111]
    ds_read_b128 v[48:51], v2 offset:10240
    s_waitcnt lgkmcnt(7)
    v_mfma_f32_16x16x32_bf16 v[76:79], v[16:19], v[52:55], v[76:79]
    v_mfma_f32_16x16x32_bf16 v[112:115], v[20:23], v[52:55], v[112:115]
    ds_read_b128 v[52:55], v2 offset:11264
    s_waitcnt lgkmcnt(7)
    v_mfma_f32_16x16x32_bf16 v[80:83], v[16:19], v[32:35], v[80:83]
    v_mfma_f32_16x16x32_bf16 v[116:119], v[20:23], v[32:35], v[116:119]
    ds_read_b128 v[32:35], v2 offset:12288
    s_waitcnt lgkmcnt(7)
    v_mfma_f32_16x16x32_bf16 v[84:87], v[16:19], v[36:39], v[84:87]
    v_mfma_f32_16x16x32_bf16 v[120:123], v[20:23], v[36:39], v[120:123]
    ds_read_b128 v[36:39], v4 offset:13312
    s_waitcnt lgkmcnt(7)
    v_mfma_f32_16x16x32_bf16 v[88:91], v[16:19], v[40:43], v[88:91]
    v_mfma_f32_16x16x32_bf16 v[124:127], v[20:23], v[40:43], v[124:127]
    ds_read_b128 v[40:43], v4 offset:14336
    s_waitcnt lgkmcnt(5)
    s_add_u32 m0, s58, 0
    s_mov_b32 s59, 768
    buffer_load_dwordx4 v1, s[20:23], s59 offen lds
    v_mfma_f32_16x16x32_bf16 v[56:59], v[24:27], v[44:47], v[56:59]
    v_mfma_f32_16x16x32_bf16 v[92:95], v[28:31], v[44:47], v[92:95]
    ds_read_b128 v[44:47], v4 offset:15360
    s_waitcnt lgkmcnt(5)
    v_mfma_f32_16x16x32_bf16 v[60:63], v[24:27], v[48:51], v[60:63]
    v_mfma_f32_16x16x32_bf16 v[96:99], v[28:31], v[48:51], v[96:99]
    ds_read_b128 v[48:51], v4 offset:16384
    s_add_u32 m0, s58, 1024
    s_mov_b32 s59, 9984
    buffer_load_dwordx4 v1, s[20:23], s59 offen lds
    s_waitcnt lgkmcnt(5)
    v_mfma_f32_16x16x32_bf16 v[64:67], v[24:27], v[52:55], v[64:67]
    v_mfma_f32_16x16x32_bf16 v[100:103], v[28:31], v[52:55], v[100:103]
    ds_read_b128 v[52:55], v2 offset:17408
    s_waitcnt lgkmcnt(5)
    v_mfma_f32_16x16x32_bf16 v[68:71], v[24:27], v[32:35], v[68:71]
    v_mfma_f32_16x16x32_bf16 v[104:107], v[28:31], v[32:35], v[104:107]
    s_waitcnt vmcnt(2)
    ds_read_b128 v[16:19], v6 offset:4096
    ds_read_b128 v[20:23], v6 offset:6144
    s_add_u32 m0, s58, 2048
    s_mov_b32 s59, 19200
    buffer_load_dwordx4 v1, s[20:23], s59 offen lds
    s_waitcnt lgkmcnt(6)
    v_mfma_f32_16x16x32_bf16 v[72:75], v[24:27], v[36:39], v[72:75]
    v_mfma_f32_16x16x32_bf16 v[108:111], v[28:31], v[36:39], v[108:111]
    s_cmp_ge_u32 s61, 6
    s_cbranch_scc1 L_cok5
L_cw5:
    ds_read_b128 v[12:15], v8 offset:16
    s_waitcnt lgkmcnt(0)
    v_min_u32 v12, v12, v13
    v_min3_u32 v12, v12, v14, v15
    s_nop 0
    v_readfirstlane_b32 s61, v12
    s_nop 0
    s_cmp_ge_u32 s61, 6
    s_cbranch_scc1 L_cok5
    s_sleep 1
    s_branch L_cw5
L_cok5:
    ds_read_b128 v[32:35], v2 offset:18432
    ds_read_b128 v[36:39], v2 offset:19456
    s_waitcnt lgkmcnt(7)
    v_mfma_f32_16x16x32_bf16 v[76:79], v[24:27], v[40:43], v[76:79]
    v_mfma_f32_16x16x32_bf16 v[112:115], v[28:31], v[40:43], v[112:115]
    ds_read_b128 v[40:43], v2 offset:20480
    s_add_u32 m0, s58, 3072
    s_mov_b32 s59, 28416
    buffer_load_dwordx4 v1, s[20:23], s59 offen lds
    s_waitcnt lgkmcnt(7)
    v_mfma_f32_16x16x32_bf16 v[80:83], v[24:27], v[44:47], v[80:83]
    v_mfma_f32_16x16x32_bf16 v[116:119], v[28:31], v[44:47], v[116:119]
    ds_read_b128 v[44:47], v2 offset:21504
    s_waitcnt lgkmcnt(7)
    v_mfma_f32_16x16x32_bf16 v[84:87], v[24:27], v[48:51], v[84:87]
    v_mfma_f32_16x16x32_bf16 v[120:123], v[28:31], v[48:51], v[120:123]
    ds_read_b128 v[48:51], v4 offset:22528
    s_waitcnt lgkmcnt(7)
    v_mov_b32 v10, 5
    s_mov_b64 exec, 1
    ds_write_b32 v9, v10
    s_mov_b64 exec, -1
    v_mfma_f32_16x16x32_bf16 v[88:91], v[24:27], v[52:55], v[88:91]
    v_mfma_f32_16x16x32_bf16 v[124:127], v[28:31], v[52:55], v[124:127]
    ds_read_b128 v[52:55], v4 offset:23552
    s_waitcnt lgkmcnt(7)
    s_waitcnt lgkmcnt(6)
    v_mfma_f32_16x16x32_bf16 v[56:59], v[16:19], v[32:35], v[56:59]
    v_mfma_f32_16x16x32_bf16 v[92:95], v[20:23], v[32:35], v[92:95]
    ds_read_b128 v[32:35], v4 offset:24576
    s_waitcnt lgkmcnt(6)
    v_mfma_f32_16x16x32_bf16 v[60:63], v[16:19], v[36:39], v[60:63]
    v_mfma_f32_16x16x32_bf16 v[96:99], v[20:23], v[36:39], v[96:99]
    ds_read_b128 v[36:39], v4 offset:25600
    s_waitcnt lgkmcnt(6)
    v_mfma_f32_16x16x32_bf16 v[64:67], v[16:19], v[40:43], v[64:67]
    v_mfma_f32_16x16x32_bf16 v[100:103], v[20:23], v[40:43], v[100:103]
    ds_read_b128 v[40:43], v2 offset:26624
    s_waitcnt lgkmcnt(6)
    v_mfma_f32_16x16x32_bf16 v[68:71], v[16:19], v[44:47], v[68:71]
    v_mfma_f32_16x16x32_bf16 v[104:107], v[20:23], v[44:47], v[104:107]
    ds_read_b128 v[44:47], v2 offset:27648
    ds_read_b128 v[24:27], v7 offset:4096
    ds_read_b128 v[28:31], v7 offset:6144
    s_waitcnt lgkmcnt(8)
    v_mfma_f32_16x16x32_bf16 v[72:75], v[16:19], v[48:51], v[72:75]
    v_mfma_f32_16x16x32_bf16 v[108:111], v[20:23], v[48:51], v[108:111]
    ds_read_b128 v[48:51], v2 offset:28672
    s_waitcnt lgkmcnt(7)
    v_mfma_f32_16x16x32_bf16 v[76:79], v[16:19], v[52:55], v[76:79]
    v_mfma_f32_16x16x32_bf16 v[112:115], v[20:23], v[52:55], v[112:115]
    ds_read_b128 v[52:55], v2 offset:29696
    s_waitcnt lgkmcnt(7)
    v_mfma_f32_16x16x32_bf16 v[80:83], v[16:19], v[32:35], v[80:83]
    v_mfma_f32_16x16x32_bf16 v[116:119], v[20:23], v[32:35], v[116:119]
    ds_read_b128 v[32:35], v2 offset:30720
    s_waitcnt lgkmcnt(7)
    v_mfma_f32_16x16x32_bf16 v[84:87], v[16:19], v[36:39], v[84:87]
    v_mfma_f32_16x16x32_bf16 v[120:123], v[20:23], v[36:39], v[120:123]
    ds_read_b128 v[36:39], v4 offset:31744
    s_waitcnt lgkmcnt(7)
    v_mfma_f32_16x16x32_bf16 v[88:91], v[16:19], v[40:43], v[88:91]
    v_mfma_f32_16x16x32_bf16 v[124:127], v[20:23], v[40:43], v[124:127]
    ds_read_b128 v[40:43], v4 offset:32768
    s_waitcnt lgkmcnt(5)
    s_add_u32 m0, s58, 4096
    s_mov_b32 s59, 896
    buffer_load_dwordx4 v1, s[20:23], s59 offen lds
    v_mfma_f32_16x16x32_bf16 v[56:59], v[24:27], v[44:47], v[56:59]
    v_mfma_f32_16x16x32_bf16 v[92:95], v[28:31], v[44:47], v[92:95]
    ds_read_b128 v[44:47], v4 offset:33792
    s_waitcnt lgkmcnt(5)
    v_mfma_f32_16x16x32_bf16 v[60:63], v[24:27], v[48:51], v[60:63]
    v_mfma_f32_16x16x32_bf16 v[96:99], v[28:31], v[48:51], v[96:99]
    ds_read_b128 v[48:51], v4 offset:34816
    s_add_u32 m0, s58, 5120
    s_mov_b32 s59, 10112
    buffer_load_dwordx4 v1, s[20:23], s59 offen lds
    s_waitcnt lgkmcnt(5)
    v_mfma_f32_16x16x32_bf16 v[64:67], v[24:27], v[52:55], v[64:67]
    v_mfma_f32_16x16x32_bf16 v[100:103], v[28:31], v[52:55], v[100:103]
    ds_read_b128 v[52:55], v2 offset:35840
    s_waitcnt lgkmcnt(5)
    v_mfma_f32_16x16x32_bf16 v[68:71], v[24:27], v[32:35], v[68:71]
    v_mfma_f32_16x16x32_bf16 v[104:107], v[28:31], v[32:35], v[104:107]
    s_waitcnt vmcnt(2)
    ds_read_b128 v[16:19], v6 offset:0
    ds_read_b128 v[20:23], v6 offset:2048
    s_add_u32 m0, s58, 6144
    s_mov_b32 s59, 19328
    buffer_load_dwordx4 v1, s[20:23], s59 offen lds
    s_waitcnt lgkmcnt(6)
    v_mfma_f32_16x16x32_bf16 v[72:75], v[24:27], v[36:39], v[72:75]
    v_mfma_f32_16x16x32_bf16 v[108:111], v[28:31], v[36:39], v[108:111]
    s_cmp_ge_u32 s60, 7
    s_cbranch_scc1 L_cok6
L_cw6:
    ds_read_b128 v[12:15], v8 offset:0
    s_waitcnt lgkmcnt(0)
    v_min_u32 v12, v12, v13
    v_min3_u32 v12, v12, v14, v15
    s_nop 0
    v_readfirstlane_b32 s60, v12
    s_nop 0
    s_cmp_ge_u32 s60, 7
    s_cbranch_scc1 L_cok6
    s_sleep 1
    s_branch L_cw6
L_cok6:
    ds_read_b128 v[32:35], v2 offset:36864
    ds_read_b128 v[36:39], v2 offset:37888
    s_waitcnt lgkmcnt(7)
    v_mfma_f32_16x16x32_bf16 v[76:79], v[24:27], v[40:43], v[76:79]
    v_mfma_f32_16x16x32_bf16 v[112:115], v[28:31], v[40:43], v[112:115]
    ds_read_b128 v[40:43], v2 offset:38912
    s_add_u32 m0, s58, 7168
    s_mov_b32 s59, 28544
    buffer_load_dwordx4 v1, s[20:23], s59 offen lds
    s_waitcnt lgkmcnt(7)
    v_mfma_f32_16x16x32_bf16 v[80:83], v[24:27], v[44:47], v[80:83]
    v_mfma_f32_16x16x32_bf16 v[116:119], v[28:31], v[44:47], v[116:119]
    ds_read_b128 v[44:47], v2 offset:39936
    s_waitcnt lgkmcnt(7)
    v_mfma_f32_16x16x32_bf16 v[84:87], v[24:27], v[48:51], v[84:87]
    v_mfma_f32_16x16x32_bf16 v[120:123], v[28:31], v[48:51], v[120:123]
    ds_read_b128 v[48:51], v4 offset:40960
    s_waitcnt lgkmcnt(7)
    v_mfma_f32_16x16x32_bf16 v[88:91], v[24:27], v[52:55], v[88:91]
    v_mfma_f32_16x16x32_bf16 v[124:127], v[28:31], v[52:55], v[124:127]
    ds_read_b128 v[52:55], v4 offset:41984
    s_waitcnt lgkmcnt(6)
    s_waitcnt lgkmcnt(5)
    v_mfma_f32_16x16x32_bf16 v[56:59], v[16:19], v[32:35], v[56:59]
    v_mfma_f32_16x16x32_bf16 v[92:95], v[20:23], v[32:35], v[92:95]
    ds_read_b128 v[32:35], v4 offset:43008
    s_waitcnt lgkmcnt(5)
    v_mfma_f32_16x16x32_bf16 v[60:63], v[16:19], v[36:39], v[60:63]
    v_mfma_f32_16x16x32_bf16 v[96:99], v[20:23], v[36:39], v[96:99]
    ds_read_b128 v[36:39], v4 offset:44032
    s_waitcnt lgkmcnt(5)
    v_mfma_f32_16x16x32_bf16 v[64:67], v[16:19], v[40:43], v[64:67]
    v_mfma_f32_16x16x32_bf16 v[100:103], v[20:23], v[40:43], v[100:103]
    ds_read_b128 v[40:43], v2 offset:45056
    s_waitcnt lgkmcnt(5)
    v_mfma_f32_16x16x32_bf16 v[68:71], v[16:19], v[44:47], v[68:71]
    v_mfma_f32_16x16x32_bf16 v[104:107], v[20:23], v[44:47], v[104:107]
    ds_read_b128 v[44:47], v2 offset:46080
    ds_read_b128 v[24:27], v7 offset:0
    ds_read_b128 v[28:31], v7 offset:2048
    s_waitcnt lgkmcnt(7)
    v_mfma_f32_16x16x32_bf16 v[72:75], v[16:19], v[48:51], v[72:75]
    v_mfma_f32_16x16x32_bf16 v[108:111], v[20:23], v[48:51], v[108:111]
    ds_read_b128 v[48:51], v2 offset:47104
    s_waitcnt lgkmcnt(7)
    v_mfma_f32_16x16x32_bf16 v[76:79], v[16:19], v[52:55], v[76:79]
    v_mfma_f32_16x16x32_bf16 v[112:115], v[20:23], v[52:55], v[112:115]
    ds_read_b128 v[52:55], v2 offset:48128
    s_waitcnt lgkmcnt(7)
    v_mfma_f32_16x16x32_bf16 v[80:83], v[16:19], v[32:35], v[80:83]
    v_mfma_f32_16x16x32_bf16 v[116:119], v[20:23], v[32:35], v[116:119]
    ds_read_b128 v[32:35], v2 offset:49152
    s_waitcnt lgkmcnt(7)
    v_mfma_f32_16x16x32_bf16 v[84:87], v[16:19], v[36:39], v[84:87]
    v_mfma_f32_16x16x32_bf16 v[120:123], v[20:23], v[36:39], v[120:123]
    ds_read_b128 v[36:39], v4 offset:50176
    s_waitcnt lgkmcnt(7)
    v_mfma_f32_16x16x32_bf16 v[88:91], v[16:19], v[40:43], v[88:91]
    v_mfma_f32_16x16x32_bf16 v[124:127], v[20:23], v[40:43], v[124:127]
    ds_read_b128 v[40:43], v4 offset:51200
    s_waitcnt lgkmcnt(5)
    s_add_u32 m0, s58, 0
    s_mov_b32 s59, 1024
    buffer_load_dwordx4 v1, s[20:23], s59 offen lds
    v_mfma_f32_16x16x32_bf16 v[56:59], v[24:27], v[44:47], v[56:59]
    v_mfma_f32_16x16x32_bf16 v[92:95], v[28:31], v[44:47], v[92:95]
    ds_read_b128 v[44:47], v4 offset:52224
    s_waitcnt lgkmcnt(5)
    v_mfma_f32_16x16x32_bf16 v[60:63], v[24:27], v[48:51], v[60:63]
    v_mfma_f32_16x16x32_bf16 v[96:99], v[28:31], v[48:51], v[96:99]
    ds_read_b128 v[48:51], v4 offset:53248
    s_add_u32 m0, s58, 1024
    s_mov_b32 s59, 10240
    buffer_load_dwordx4 v1, s[20:23], s59 offen lds
    s_waitcnt lgkmcnt(5)
    v_mfma_f32_16x16x32_bf16 v[64:67], v[24:27], v[52:55], v[64:67]
    v_mfma_f32_16x16x32_bf16 v[100:103], v[28:31], v[52:55], v[100:103]
    ds_read_b128 v[52:55], v2 offset:54272
    s_waitcnt lgkmcnt(5)
    v_mfma_f32_16x16x32_bf16 v[68:71], v[24:27], v[32:35], v[68:71]
    v_mfma_f32_16x16x32_bf16 v[104:107], v[28:31], v[32:35], v[104:107]
    s_waitcnt vmcnt(2)
    ds_read_b128 v[16:19], v6 offset:4096
    ds_read_b128 v[20:23], v6 offset:6144
    s_add_u32 m0, s58, 2048
    s_mov_b32 s59, 19456
    buffer_load_dwordx4 v1, s[20:23], s59 offen lds
    s_waitcnt lgkmcnt(6)
    v_mfma_f32_16x16x32_bf16 v[72:75], v[24:27], v[36:39], v[72:75]
    v_mfma_f32_16x16x32_bf16 v[108:111], v[28:31], v[36:39], v[108:111]
    s_cmp_ge_u32 s61, 8
    s_cbranch_scc1 L_cok7
L_cw7:
    ds_read_b128 v[12:15], v8 offset:16
    s_waitcnt lgkmcnt(0)
    v_min_u32 v12, v12, v13
    v_min3_u32 v12, v12, v14, v15
    s_nop 0
    v_readfirstlane_b32 s61, v12
    s_nop 0
    s_cmp_ge_u32 s61, 8
    s_cbranch_scc1 L_cok7
    s_sleep 1
    s_branch L_cw7
L_cok7:
    ds_read_b128 v[32:35], v2 offset:55296
    ds_read_b128 v[36:39], v2 offset:56320
    s_waitcnt lgkmcnt(7)
    v_mfma_f32_16x16x32_bf16 v[76:79], v[24:27], v[40:43], v[76:79]
    v_mfma_f32_16x16x32_bf16 v[112:115], v[28:31], v[40:43], v[112:115]
    ds_read_b128 v[40:43], v2 offset:57344
    s_add_u32 m0, s58, 3072
    s_mov_b32 s59, 28672
    buffer_load_dwordx4 v1, s[20:23], s59 offen lds
    s_waitcnt lgkmcnt(7)
    v_mfma_f32_16x16x32_bf16 v[80:83], v[24:27], v[44:47], v[80:83]
    v_mfma_f32_16x16x32_bf16 v[116:119], v[28:31], v[44:47], v[116:119]
    ds_read_b128 v[44:47], v2 offset:58368
    s_waitcnt lgkmcnt(7)
    v_mfma_f32_16x16x32_bf16 v[84:87], v[24:27], v[48:51], v[84:87]
    v_mfma_f32_16x16x32_bf16 v[120:123], v[28:31], v[48:51], v[120:123]
    ds_read_b128 v[48:51], v4 offset:59392
    s_waitcnt lgkmcnt(7)
    v_mfma_f32_16x16x32_bf16 v[88:91], v[24:27], v[52:55], v[88:91]
    v_mfma_f32_16x16x32_bf16 v[124:127], v[28:31], v[52:55], v[124:127]
    ds_read_b128 v[52:55], v4 offset:60416
    s_waitcnt lgkmcnt(6)
    s_waitcnt lgkmcnt(5)
    v_mfma_f32_16x16x32_bf16 v[56:59], v[16:19], v[32:35], v[56:59]
    v_mfma_f32_16x16x32_bf16 v[92:95], v[20:23], v[32:35], v[92:95]
    ds_read_b128 v[32:35], v4 offset:61440
    s_waitcnt lgkmcnt(5)
    v_mfma_f32_16x16x32_bf16 v[60:63], v[16:19], v[36:39], v[60:63]
    v_mfma_f32_16x16x32_bf16 v[96:99], v[20:23], v[36:39], v[96:99]
    ds_read_b128 v[36:39], v4 offset:62464
    s_waitcnt lgkmcnt(5)
    v_mfma_f32_16x16x32_bf16 v[64:67], v[16:19], v[40:43], v[64:67]
    v_mfma_f32_16x16x32_bf16 v[100:103], v[20:23], v[40:43], v[100:103]
    ds_read_b128 v[40:43], v2 offset:63488
    s_waitcnt lgkmcnt(5)
    v_mfma_f32_16x16x32_bf16 v[68:71], v[16:19], v[44:47], v[68:71]
    v_mfma_f32_16x16x32_bf16 v[104:107], v[20:23], v[44:47], v[104:107]
    ds_read_b128 v[44:47], v2 offset:64512
    ds_read_b128 v[24:27], v7 offset:4096
    ds_read_b128 v[28:31], v7 offset:6144
    s_waitcnt lgkmcnt(7)
    v_mfma_f32_16x16x32_bf16 v[72:75], v[16:19], v[48:51], v[72:75]
    v_mfma_f32_16x16x32_bf16 v[108:111], v[20:23], v[48:51], v[108:111]
    ds_read_b128 v[48:51], v3 offset:0
    s_waitcnt lgkmcnt(7)
    v_mfma_f32_16x16x32_bf16 v[76:79], v[16:19], v[52:55], v[76:79]
    v_mfma_f32_16x16x32_bf16 v[112:115], v[20:23], v[52:55], v[112:115]
    ds_read_b128 v[52:55], v3 offset:1024
    s_waitcnt lgkmcnt(7)
    v_mfma_f32_16x16x32_bf16 v[80:83], v[16:19], v[32:35], v[80:83]
    v_mfma_f32_16x16x32_bf16 v[116:119], v[20:23], v[32:35], v[116:119]
    ds_read_b128 v[32:35], v3 offset:2048
    s_waitcnt lgkmcnt(7)
    v_mfma_f32_16x16x32_bf16 v[84:87], v[16:19], v[36:39], v[84:87]
    v_mfma_f32_16x16x32_bf16 v[120:123], v[20:23], v[36:39], v[120:123]
    ds_read_b128 v[36:39], v5 offset:3072
    s_waitcnt lgkmcnt(7)
    v_mfma_f32_16x16x32_bf16 v[88:91], v[16:19], v[40:43], v[88:91]
    v_mfma_f32_16x16x32_bf16 v[124:127], v[20:23], v[40:43], v[124:127]
    ds_read_b128 v[40:43], v5 offset:4096
    s_waitcnt lgkmcnt(5)
    v_mfma_f32_16x16x32_bf16 v[56:59], v[24:27], v[44:47], v[56:59]
    v_mfma_f32_16x16x32_bf16 v[92:95], v[28:31], v[44:47], v[92:95]
    ds_read_b128 v[44:47], v5 offset:5120
    s_waitcnt lgkmcnt(5)
    v_mfma_f32_16x16x32_bf16 v[60:63], v[24:27], v[48:51], v[60:63]
    v_mfma_f32_16x16x32_bf16 v[96:99], v[28:31], v[48:51], v[96:99]
    ds_read_b128 v[48:51], v5 offset:6144
    s_waitcnt lgkmcnt(5)
    v_mfma_f32_16x16x32_bf16 v[64:67], v[24:27], v[52:55], v[64:67]
    v_mfma_f32_16x16x32_bf16 v[100:103], v[28:31], v[52:55], v[100:103]
    ds_read_b128 v[52:55], v3 offset:7168
    s_waitcnt lgkmcnt(5)
    v_mfma_f32_16x16x32_bf16 v[68:71], v[24:27], v[32:35], v[68:71]
    v_mfma_f32_16x16x32_bf16 v[104:107], v[28:31], v[32:35], v[104:107]
    s_waitcnt vmcnt(0)
    ds_read_b128 v[16:19], v6 offset:0
    ds_read_b128 v[20:23], v6 offset:2048
    s_waitcnt lgkmcnt(6)
    v_mfma_f32_16x16x32_bf16 v[72:75], v[24:27], v[36:39], v[72:75]
    v_mfma_f32_16x16x32_bf16 v[108:111], v[28:31], v[36:39], v[108:111]
    s_cmp_ge_u32 s60, 9
    s_cbranch_scc1 L_cok8
L_cw8:
    ds_read_b128 v[12:15], v8 offset:0
    s_waitcnt lgkmcnt(0)
    v_min_u32 v12, v12, v13
    v_min3_u32 v12, v12, v14, v15
    s_nop 0
    v_readfirstlane_b32 s60, v12
    s_nop 0
    s_cmp_ge_u32 s60, 9
    s_cbranch_scc1 L_cok8
    s_sleep 1
    s_branch L_cw8
L_cok8:
    ds_read_b128 v[32:35], v2 offset:0
    ds_read_b128 v[36:39], v2 offset:1024
    s_waitcnt lgkmcnt(7)
    v_mfma_f32_16x16x32_bf16 v[76:79], v[24:27], v[40:43], v[76:79]
    v_mfma_f32_16x16x32_bf16 v[112:115], v[28:31], v[40:43], v[112:115]
    ds_read_b128 v[40:43], v2 offset:2048
    s_waitcnt lgkmcnt(7)
    v_mfma_f32_16x16x32_bf16 v[80:83], v[24:27], v[44:47], v[80:83]
    v_mfma_f32_16x16x32_bf16 v[116:119], v[28:31], v[44:47], v[116:119]
    ds_read_b128 v[44:47], v2 offset:3072
    s_waitcnt lgkmcnt(7)
    v_mfma_f32_16x16x32_bf16 v[84:87], v[24:27], v[48:51], v[84:87]
    v_mfma_f32_16x16x32_bf16 v[120:123], v[28:31], v[48:51], v[120:123]
    ds_read_b128 v[48:51], v4 offset:4096
    s_waitcnt lgkmcnt(7)
    v_mfma_f32_16x16x32_bf16 v[88:91], v[24:27], v[52:55], v[88:91]
    v_mfma_f32_16x16x32_bf16 v[124:127], v[28:31], v[52:55], v[124:127]
    ds_read_b128 v[52:55], v4 offset:5120
    s_waitcnt lgkmcnt(6)
    s_waitcnt lgkmcnt(5)
    v_mfma_f32_16x16x32_bf16 v[56:59], v[16:19], v[32:35], v[56:59]
    v_mfma_f32_16x16x32_bf16 v[92:95], v[20:23], v[32:35], v[92:95]
    ds_read_b128 v[32:35], v4 offset:6144
    s_waitcnt lgkmcnt(5)
    v_mfma_f32_16x16x32_bf16 v[60:63], v[16:19], v[36:39], v[60:63]
    v_mfma_f32_16x16x32_bf16 v[96:99], v[20:23], v[36:39], v[96:99]
    ds_read_b128 v[36:39], v4 offset:7168
    s_waitcnt lgkmcnt(5)
    v_mfma_f32_16x16x32_bf16 v[64:67], v[16:19], v[40:43], v[64:67]
    v_mfma_f32_16x16x32_bf16 v[100:103], v[20:23], v[40:43], v[100:103]
    ds_read_b128 v[40:43], v2 offset:8192
    s_waitcnt lgkmcnt(5)
    v_mfma_f32_16x16x32_bf16 v[68:71], v[16:19], v[44:47], v[68:71]
    v_mfma_f32_16x16x32_bf16 v[104:107], v[20:23], v[44:47], v[104:107]
    ds_read_b128 v[44:47], v2 offset:9216
    ds_read_b128 v[24:27], v7 offset:0
    ds_read_b128 v[28:31], v7 offset:2048
    s_waitcnt lgkmcnt(7)
    v_mfma_f32_16x16x32_bf16 v[72:75], v[16:19], v[48:51], v[72:75]
    v_mfma_f32_16x16x32_bf16 v[108:111], v[20:23], v[48:51], v[108:111]
    ds_read_b128 v[48:51], v2 offset:10240
    s_waitcnt lgkmcnt(7)
    v_mfma_f32_16x16x32_bf16 v[76:79], v[16:19], v[52:55], v[76:79]
    v_mfma_f32_16x16x32_bf16 v[112:115], v[20:23], v[52:55], v[112:115]
    ds_read_b128 v[52:55], v2 offset:11264
    s_waitcnt lgkmcnt(7)
    v_mfma_f32_16x16x32_bf16 v[80:83], v[16:19], v[32:35], v[80:83]
    v_mfma_f32_16x16x32_bf16 v[116:119], v[20:23], v[32:35], v[116:119]
    ds_read_b128 v[32:35], v2 offset:12288
    s_waitcnt lgkmcnt(7)
    v_mfma_f32_16x16x32_bf16 v[84:87], v[16:19], v[36:39], v[84:87]
    v_mfma_f32_16x16x32_bf16 v[120:123], v[20:23], v[36:39], v[120:123]
    ds_read_b128 v[36:39], v4 offset:13312
    s_waitcnt lgkmcnt(7)
    v_mfma_f32_16x16x32_bf16 v[88:91], v[16:19], v[40:43], v[88:91]
    v_mfma_f32_16x16x32_bf16 v[124:127], v[20:23], v[40:43], v[124:127]
    ds_read_b128 v[40:43], v4 offset:14336
    s_waitcnt lgkmcnt(5)
    v_mfma_f32_16x16x32_bf16 v[56:59], v[24:27], v[44:47], v[56:59]
    v_mfma_f32_16x16x32_bf16 v[92:95], v[28:31], v[44:47], v[92:95]
    ds_read_b128 v[44:47], v4 offset:15360
    s_waitcnt lgkmcnt(5)
    v_mfma_f32_16x16x32_bf16 v[60:63], v[24:27], v[48:51], v[60:63]
    v_mfma_f32_16x16x32_bf16 v[96:99], v[28:31], v[48:51], v[96:99]
    ds_read_b128 v[48:51], v4 offset:16384
    s_waitcnt lgkmcnt(5)
    v_mfma_f32_16x16x32_bf16 v[64:67], v[24:27], v[52:55], v[64:67]
    v_mfma_f32_16x16x32_bf16 v[100:103], v[28:31], v[52:55], v[100:103]
    ds_read_b128 v[52:55], v2 offset:17408
    s_waitcnt lgkmcnt(5)
    v_mfma_f32_16x16x32_bf16 v[68:71], v[24:27], v[32:35], v[68:71]
    v_mfma_f32_16x16x32_bf16 v[104:107], v[28:31], v[32:35], v[104:107]
    s_waitcnt lgkmcnt(4)
    v_mfma_f32_16x16x32_bf16 v[72:75], v[24:27], v[36:39], v[72:75]
    v_mfma_f32_16x16x32_bf16 v[108:111], v[28:31], v[36:39], v[108:111]
    s_waitcnt lgkmcnt(3)
    v_mfma_f32_16x16x32_bf16 v[76:79], v[24:27], v[40:43], v[76:79]
    v_mfma_f32_16x16x32_bf16 v[112:115], v[28:31], v[40:43], v[112:115]
    s_waitcnt lgkmcnt(2)
    v_mfma_f32_16x16x32_bf16 v[80:83], v[24:27], v[44:47], v[80:83]
    v_mfma_f32_16x16x32_bf16 v[116:119], v[28:31], v[44:47], v[116:119]
    s_waitcnt lgkmcnt(1)
    v_mfma_f32_16x16x32_bf16 v[84:87], v[24:27], v[48:51], v[84:87]
    v_mfma_f32_16x16x32_bf16 v[120:123], v[28:31], v[48:51], v[120:123]
    s_waitcnt lgkmcnt(0)
    v_mfma_f32_16x16x32_bf16 v[88:91], v[24:27], v[52:55], v[88:91]
    v_mfma_f32_16x16x32_bf16 v[124:127], v[28:31], v[52:55], v[124:127]
    v_and_b32 v3, 15, v0
    v_bfe_u32 v4, v0, 4, 2
    s_mul_i32 s17, s53, 294912
    s_add_u32 s17, s17, s55
    v_mul_u32_u24 v1, 36864, v4
    v_add_u32 v1, s17, v1
    v_lshl_add_u32 v2, v3, 1, v1
    v_add_u32 v2, 256, v2
    v_lshl_add_u32 v1, v3, 4, v1
    s_nop 3
    v_cvt_pk_bf16_f32 v8, v56, v60
    v_cvt_pk_bf16_f32 v9, v64, v68
    v_cvt_pk_bf16_f32 v10, v72, v76
    v_cvt_pk_bf16_f32 v11, v80, v84
    s_mov_b32 s59, 0
    buffer_store_dwordx4 v[8:11], v1, s[36:39], s59 offen
    v_cvt_pk_bf16_f32 v12, v88, v88
    buffer_store_short v12, v2, s[36:39], s59 offen
    v_cvt_pk_bf16_f32 v14, v57, v61
    v_cvt_pk_bf16_f32 v15, v65, v69
    v_cvt_pk_bf16_f32 v16, v73, v77
    v_cvt_pk_bf16_f32 v17, v81, v85
    s_mov_b32 s59, 9216
    buffer_store_dwordx4 v[14:17], v1, s[36:39], s59 offen
    v_cvt_pk_bf16_f32 v18, v89, v89
    buffer_store_short v18, v2, s[36:39], s59 offen
    v_cvt_pk_bf16_f32 v20, v58, v62
    v_cvt_pk_bf16_f32 v21, v66, v70
    v_cvt_pk_bf16_f32 v22, v74, v78
    v_cvt_pk_bf16_f32 v23, v82, v86
    s_mov_b32 s59, 18432
    buffer_store_dwordx4 v[20:23], v1, s[36:39], s59 offen
    v_cvt_pk_bf16_f32 v24, v90, v90
    buffer_store_short v24, v2, s[36:39], s59 offen
    v_cvt_pk_bf16_f32 v26, v59, v63
    v_cvt_pk_bf16_f32 v27, v67, v71
    v_cvt_pk_bf16_f32 v28, v75, v79
    v_cvt_pk_bf16_f32 v29, v83, v87
    s_mov_b32 s59, 27648
    buffer_store_dwordx4 v[26:29], v1, s[36:39], s59 offen
    v_cvt_pk_bf16_f32 v30, v91, v91
    buffer_store_short v30, v2, s[36:39], s59 offen
    v_cvt_pk_bf16_f32 v32, v92, v96
    v_cvt_pk_bf16_f32 v33, v100, v104
    v_cvt_pk_bf16_f32 v34, v108, v112
    v_cvt_pk_bf16_f32 v35, v116, v120
    s_mov_b32 s59, 147456
    buffer_store_dwordx4 v[32:35], v1, s[36:39], s59 offen
    v_cvt_pk_bf16_f32 v36, v124, v124
    buffer_store_short v36, v2, s[36:39], s59 offen
    v_cvt_pk_bf16_f32 v38, v93, v97
    v_cvt_pk_bf16_f32 v39, v101, v105
    v_cvt_pk_bf16_f32 v40, v109, v113
    v_cvt_pk_bf16_f32 v41, v117, v121
    s_mov_b32 s59, 156672
    buffer_store_dwordx4 v[38:41], v1, s[36:39], s59 offen
    v_cvt_pk_bf16_f32 v42, v125, v125
    buffer_store_short v42, v2, s[36:39], s59 offen
    v_cvt_pk_bf16_f32 v44, v94, v98
    v_cvt_pk_bf16_f32 v45, v102, v106
    v_cvt_pk_bf16_f32 v46, v110, v114
    v_cvt_pk_bf16_f32 v47, v118, v122
    s_mov_b32 s59, 165888
    buffer_store_dwordx4 v[44:47], v1, s[36:39], s59 offen
    v_cvt_pk_bf16_f32 v48, v126, v126
    buffer_store_short v48, v2, s[36:39], s59 offen
    v_cvt_pk_bf16_f32 v50, v95, v99
    v_cvt_pk_bf16_f32 v51, v103, v107
    v_cvt_pk_bf16_f32 v52, v111, v115
    v_cvt_pk_bf16_f32 v53, v119, v123
    s_mov_b32 s59, 175104
    buffer_store_dwordx4 v[50:53], v1, s[36:39], s59 offen
    v_cvt_pk_bf16_f32 v54, v127, v127
    buffer_store_short v54, v2, s[36:39], s59 offen
    s_endpgm
L_prod0:
    v_add_u32 v9, -512, v0
    s_mov_b32 s44, 0
    s_mov_b32 s45, 18432
    s_mov_b32 s46, 36864
    s_mov_b32 s47, 55296
    s_mov_b32 s48, 73728
    s_mov_b32 s49, 92160
    s_mov_b32 s50, 110592
    s_mov_b32 s51, 129024
    v_lshrrev_b32 v10, 5, v9
    v_and_b32 v11, 31, v9
    v_mul_u32_u24 v1, 147456, v10
    v_lshl_add_u32 v1, v11, 4, v1
    v_add_u32 v1, s54, v1
    v_lshlrev_b32 v2, 3, v11
    v_add_u32 v2, s55, v2
    v_lshlrev_b32 v92, 4, v11
    v_add_u32 v92, 139264, v92
    v_lshrrev_b32 v12, 2, v10
    v_mul_u32_u24 v5, 9216, v12
    v_and_b32 v12, 3, v10
    v_lshl_add_u32 v5, v12, 8, v5
    v_and_b32 v12, 1, v11
    v_lshl_add_u32 v5, v12, 12, v5
    v_lshlrev_b32 v12, 2, v12
    v_lshrrev_b32 v11, 1, v11
    v_xor_b32 v12, v12, v11
    v_lshl_add_u32 v5, v12, 4, v5
    v_add_u32 v6, 65536, v5
    v_lshrrev_b32 v10, 2, v9
    v_and_b32 v11, 3, v9
    v_mul_u32_u24 v3, 18432, v10
    v_lshl_add_u32 v3, v11, 4, v3
    v_add_u32 v3, s54, v3
    v_add_u32 v3, 512, v3
    v_lshlrev_b32 v4, 3, v11
    v_add_u32 v4, s55, v4
    v_add_u32 v4, 256, v4
    v_lshlrev_b32 v93, 4, v11
    v_add_u32 v93, 139776, v93
    v_lshrrev_b32 v12, 5, v10
    v_mul_u32_u24 v7, 9216, v12
    v_bfe_u32 v12, v10, 3, 2
    v_lshl_add_u32 v7, v12, 8, v7
    v_lshl_add_u32 v7, v11, 6, v7
    v_and_b32 v12, 7, v10
    v_lshl_add_u32 v7, v12, 1, v7
    v_add_u32 v7, 8192, v7
    v_add_u32 v8, 65536, v7
    v_mov_b32 v13, 149632
    s_lshl_b32 s17, s56, 2
    s_add_u32 s17, s17, 149600
    v_mov_b32 v14, s17
    v_mov_b32 v15, 0
    ds_write_b32 v14, v15
    buffer_load_dwordx4 v[16:19], v1, s[24:27], s44 offen
    buffer_load_dwordx4 v[20:23], v1, s[24:27], s45 offen
    buffer_load_dwordx4 v[24:27], v1, s[24:27], s46 offen
    buffer_load_dwordx4 v[28:31], v1, s[24:27], s47 offen
    buffer_load_dwordx4 v[32:35], v1, s[24:27], s48 offen
    buffer_load_dwordx4 v[36:39], v1, s[24:27], s49 offen
    buffer_load_dwordx4 v[40:43], v1, s[24:27], s50 offen
    buffer_load_dwordx4 v[44:47], v1, s[24:27], s51 offen
    buffer_load_dwordx4 v[48:51], v3, s[24:27], 0 offen
    v_add_u32 v1, 2359296, v1
    v_add_u32 v3, 2359296, v3
    s_waitcnt lgkmcnt(0)
    s_barrier
    ds_read_b128 v[100:103], v13 offset:64
    ds_read_b128 v[104:107], v13 offset:80
    s_waitcnt lgkmcnt(0)
    v_or3_b32 v100, v100, v101, v102
    v_or3_b32 v100, v100, v103, v104
    v_or3_b32 v100, v100, v105, v106
    v_or_b32 v100, v100, v107
    s_nop 0
    v_readfirstlane_b32 s52, v100
    ds_read_b128 v[60:63], v92 offset:0
    ds_read_b128 v[68:71], v92 offset:5184
    ds_read_b128 v[64:67], v93 offset:0
    ds_read_b128 v[72:75], v93 offset:5184
    s_waitcnt vmcnt(0)
    v_or3_b32 v12, v16, v17, v18
    v_or3_b32 v94, v25, v26, v27
    v_or3_b32 v95, v34, v35, v36
    v_or3_b32 v96, v43, v44, v45
    v_or3_b32 v12, v12, v19, v20
    v_or3_b32 v94, v94, v28, v29
    v_or3_b32 v95, v95, v37, v38
    v_or3_b32 v96, v96, v46, v47
    v_or3_b32 v12, v12, v21, v22
    v_or3_b32 v94, v94, v30, v31
    v_or3_b32 v95, v95, v39, v40
    v_or3_b32 v96, v96, v48, v49
    v_or3_b32 v12, v12, v23, v24
    v_or3_b32 v94, v94, v32, v33
    v_or3_b32 v95, v95, v41, v42
    v_or3_b32 v96, v96, v50, v51
    v_or3_b32 v12, v12, v94, v95
    v_or_b32 v12, v12, v96
    v_and_b32 v12, 0xffffff80, v12
    v_cmp_ne_u32 vcc, 0, v12
    s_nop 1
    s_cmp_lg_u64 vcc, 0
    s_cbranch_scc1 L_slow0
    s_cmp_lg_u32 s52, 0
    s_cbranch_scc1 L_slow0
    s_waitcnt lgkmcnt(0)
    v_fma_mix_f32 v16, v16, v60, v68 op_sel_hi:[1,0,0]
    v_fma_mix_f32 v17, v17, v61, v69 op_sel_hi:[1,0,0]
    v_fma_mix_f32 v18, v18, v62, v70 op_sel_hi:[1,0,0]
    v_fma_mix_f32 v19, v19, v63, v71 op_sel_hi:[1,0,0]
    v_fma_mix_f32 v20, v20, v60, v68 op_sel_hi:[1,0,0]
    v_fma_mix_f32 v21, v21, v61, v69 op_sel_hi:[1,0,0]
    v_fma_mix_f32 v22, v22, v62, v70 op_sel_hi:[1,0,0]
    v_fma_mix_f32 v23, v23, v63, v71 op_sel_hi:[1,0,0]
    v_cvt_pk_bf16_f32 v76, v16, v20
    v_cvt_pk_bf16_f32 v80, v17, v21
    v_cvt_pk_bf16_f32 v84, v18, v22
    v_cvt_pk_bf16_f32 v88, v19, v23
    buffer_load_dwordx4 v[16:19], v1, s[24:27], s44 offen
    buffer_load_dwordx4 v[20:23], v1, s[24:27], s45 offen
    v_fma_mix_f32 v24, v24, v60, v68 op_sel_hi:[1,0,0]
    v_fma_mix_f32 v25, v25, v61, v69 op_sel_hi:[1,0,0]
    v_fma_mix_f32 v26, v26, v62, v70 op_sel_hi:[1,0,0]
    v_fma_mix_f32 v27, v27, v63, v71 op_sel_hi:[1,0,0]
    v_fma_mix_f32 v28, v28, v60, v68 op_sel_hi:[1,0,0]
    v_fma_mix_f32 v29, v29, v61, v69 op_sel_hi:[1,0,0]
    v_fma_mix_f32 v30, v30, v62, v70 op_sel_hi:[1,0,0]
    v_fma_mix_f32 v31, v31, v63, v71 op_sel_hi:[1,0,0]
    v_cvt_pk_bf16_f32 v77, v24, v28
    v_cvt_pk_bf16_f32 v81, v25, v29
    v_cvt_pk_bf16_f32 v85, v26, v30
    v_cvt_pk_bf16_f32 v89, v27, v31
    buffer_load_dwordx4 v[24:27], v1, s[24:27], s46 offen
    buffer_load_dwordx4 v[28:31], v1, s[24:27], s47 offen
    v_fma_mix_f32 v32, v32, v60, v68 op_sel_hi:[1,0,0]
    v_fma_mix_f32 v33, v33, v61, v69 op_sel_hi:[1,0,0]
    v_fma_mix_f32 v34, v34, v62, v70 op_sel_hi:[1,0,0]
    v_fma_mix_f32 v35, v35, v63, v71 op_sel_hi:[1,0,0]
    v_fma_mix_f32 v36, v36, v60, v68 op_sel_hi:[1,0,0]
    v_fma_mix_f32 v37, v37, v61, v69 op_sel_hi:[1,0,0]
    v_fma_mix_f32 v38, v38, v62, v70 op_sel_hi:[1,0,0]
    v_fma_mix_f32 v39, v39, v63, v71 op_sel_hi:[1,0,0]
    v_cvt_pk_bf16_f32 v78, v32, v36
    v_cvt_pk_bf16_f32 v82, v33, v37
    v_cvt_pk_bf16_f32 v86, v34, v38
    v_cvt_pk_bf16_f32 v90, v35, v39
    buffer_load_dwordx4 v[32:35], v1, s[24:27], s48 offen
    buffer_load_dwordx4 v[36:39], v1, s[24:27], s49 offen
    v_fma_mix_f32 v40, v40, v60, v68 op_sel_hi:[1,0,0]
    v_fma_mix_f32 v41, v41, v61, v69 op_sel_hi:[1,0,0]
    v_fma_mix_f32 v42, v42, v62, v70 op_sel_hi:[1,0,0]
    v_fma_mix_f32 v43, v43, v63, v71 op_sel_hi:[1,0,0]
    v_fma_mix_f32 v44, v44, v60, v68 op_sel_hi:[1,0,0]
    v_fma_mix_f32 v45, v45, v61, v69 op_sel_hi:[1,0,0]
    v_fma_mix_f32 v46, v46, v62, v70 op_sel_hi:[1,0,0]
    v_fma_mix_f32 v47, v47, v63, v71 op_sel_hi:[1,0,0]
    v_cvt_pk_bf16_f32 v79, v40, v44
    v_cvt_pk_bf16_f32 v83, v41, v45
    v_cvt_pk_bf16_f32 v87, v42, v46
    v_cvt_pk_bf16_f32 v91, v43, v47
    buffer_load_dwordx4 v[40:43], v1, s[24:27], s50 offen
    buffer_load_dwordx4 v[44:47], v1, s[24:27], s51 offen
    v_fma_mix_f32 v48, v48, v64, v72 op_sel_hi:[1,0,0]
    v_fma_mix_f32 v49, v49, v65, v73 op_sel_hi:[1,0,0]
    v_fma_mix_f32 v50, v50, v66, v74 op_sel_hi:[1,0,0]
    v_fma_mix_f32 v51, v51, v67, v75 op_sel_hi:[1,0,0]
    v_cvt_pk_bf16_f32 v48, v48, v48
    v_cvt_pk_bf16_f32 v49, v49, v49
    v_cvt_pk_bf16_f32 v50, v50, v50
    v_cvt_pk_bf16_f32 v51, v51, v51
L_join0:
    ds_write_b128 v5, v[76:79] offset:0
    ds_write_b128 v5, v[80:83] offset:1024
    ds_write_b128 v5, v[84:87] offset:2048
    ds_write_b128 v5, v[88:91] offset:3072
    ds_write_b16 v7, v48 offset:0
    ds_write_b16 v7, v49 offset:16
    ds_write_b16 v7, v50 offset:32
    ds_write_b16 v7, v51 offset:48
    buffer_load_dwordx4 v[48:51], v3, s[24:27], 0 offen
    v_add_u32 v1, 2359296, v1
    v_add_u32 v3, 2359296, v3
    s_waitcnt lgkmcnt(0)
    v_mov_b32 v15, 1
    s_mov_b64 exec, 1
    ds_write_b32 v14, v15
    s_mov_b64 exec, -1
    ds_read_b128 v[60:63], v92 offset:1152
    ds_read_b128 v[68:71], v92 offset:6336
    ds_read_b128 v[64:67], v93 offset:1152
    ds_read_b128 v[72:75], v93 offset:6336
    s_waitcnt vmcnt(0)
    v_or3_b32 v12, v16, v17, v18
    v_or3_b32 v94, v25, v26, v27
    v_or3_b32 v95, v34, v35, v36
    v_or3_b32 v96, v43, v44, v45
    v_or3_b32 v12, v12, v19, v20
    v_or3_b32 v94, v94, v28, v29
    v_or3_b32 v95, v95, v37, v38
    v_or3_b32 v96, v96, v46, v47
    v_or3_b32 v12, v12, v21, v22
    v_or3_b32 v94, v94, v30, v31
    v_or3_b32 v95, v95, v39, v40
    v_or3_b32 v96, v96, v48, v49
    v_or3_b32 v12, v12, v23, v24
    v_or3_b32 v94, v94, v32, v33
    v_or3_b32 v95, v95, v41, v42
    v_or3_b32 v96, v96, v50, v51
    v_or3_b32 v12, v12, v94, v95
    v_or_b32 v12, v12, v96
    v_and_b32 v12, 0xffffff80, v12
    v_cmp_ne_u32 vcc, 0, v12
    s_nop 1
    s_cmp_lg_u64 vcc, 0
    s_cbranch_scc1 L_slow2
    s_cmp_lg_u32 s52, 0
    s_cbranch_scc1 L_slow2
    s_waitcnt lgkmcnt(0)
    v_fma_mix_f32 v16, v16, v60, v68 op_sel_hi:[1,0,0]
    v_fma_mix_f32 v17, v17, v61, v69 op_sel_hi:[1,0,0]
    v_fma_mix_f32 v18, v18, v62, v70 op_sel_hi:[1,0,0]
    v_fma_mix_f32 v19, v19, v63, v71 op_sel_hi:[1,0,0]
    v_fma_mix_f32 v20, v20, v60, v68 op_sel_hi:[1,0,0]
    v_fma_mix_f32 v21, v21, v61, v69 op_sel_hi:[1,0,0]
    v_fma_mix_f32 v22, v22, v62, v70 op_sel_hi:[1,0,0]
    v_fma_mix_f32 v23, v23, v63, v71 op_sel_hi:[1,0,0]
    v_cvt_pk_bf16_f32 v76, v16, v20
    v_cvt_pk_bf16_f32 v80, v17, v21
    v_cvt_pk_bf16_f32 v84, v18, v22
    v_cvt_pk_bf16_f32 v88, v19, v23
    buffer_load_dwordx4 v[16:19], v1, s[24:27], s44 offen
    buffer_load_dwordx4 v[20:23], v1, s[24:27], s45 offen
    v_fma_mix_f32 v24, v24, v60, v68 op_sel_hi:[1,0,0]
    v_fma_mix_f32 v25, v25, v61, v69 op_sel_hi:[1,0,0]
    v_fma_mix_f32 v26, v26, v62, v70 op_sel_hi:[1,0,0]
    v_fma_mix_f32 v27, v27, v63, v71 op_sel_hi:[1,0,0]
    v_fma_mix_f32 v28, v28, v60, v68 op_sel_hi:[1,0,0]
    v_fma_mix_f32 v29, v29, v61, v69 op_sel_hi:[1,0,0]
    v_fma_mix_f32 v30, v30, v62, v70 op_sel_hi:[1,0,0]
    v_fma_mix_f32 v31, v31, v63, v71 op_sel_hi:[1,0,0]
    v_cvt_pk_bf16_f32 v77, v24, v28
    v_cvt_pk_bf16_f32 v81, v25, v29
    v_cvt_pk_bf16_f32 v85, v26, v30
    v_cvt_pk_bf16_f32 v89, v27, v31
    buffer_load_dwordx4 v[24:27], v1, s[24:27], s46 offen
    buffer_load_dwordx4 v[28:31], v1, s[24:27], s47 offen
    v_fma_mix_f32 v32, v32, v60, v68 op_sel_hi:[1,0,0]
    v_fma_mix_f32 v33, v33, v61, v69 op_sel_hi:[1,0,0]
    v_fma_mix_f32 v34, v34, v62, v70 op_sel_hi:[1,0,0]
    v_fma_mix_f32 v35, v35, v63, v71 op_sel_hi:[1,0,0]
    v_fma_mix_f32 v36, v36, v60, v68 op_sel_hi:[1,0,0]
    v_fma_mix_f32 v37, v37, v61, v69 op_sel_hi:[1,0,0]
    v_fma_mix_f32 v38, v38, v62, v70 op_sel_hi:[1,0,0]
    v_fma_mix_f32 v39, v39, v63, v71 op_sel_hi:[1,0,0]
    v_cvt_pk_bf16_f32 v78, v32, v36
    v_cvt_pk_bf16_f32 v82, v33, v37
    v_cvt_pk_bf16_f32 v86, v34, v38
    v_cvt_pk_bf16_f32 v90, v35, v39
    buffer_load_dwordx4 v[32:35], v1, s[24:27], s48 offen
    buffer_load_dwordx4 v[36:39], v1, s[24:27], s49 offen
    v_fma_mix_f32 v40, v40, v60, v68 op_sel_hi:[1,0,0]
    v_fma_mix_f32 v41, v41, v61, v69 op_sel_hi:[1,0,0]
    v_fma_mix_f32 v42, v42, v62, v70 op_sel_hi:[1,0,0]
    v_fma_mix_f32 v43, v43, v63, v71 op_sel_hi:[1,0,0]
    v_fma_mix_f32 v44, v44, v60, v68 op_sel_hi:[1,0,0]
    v_fma_mix_f32 v45, v45, v61, v69 op_sel_hi:[1,0,0]
    v_fma_mix_f32 v46, v46, v62, v70 op_sel_hi:[1,0,0]
    v_fma_mix_f32 v47, v47, v63, v71 op_sel_hi:[1,0,0]
    v_cvt_pk_bf16_f32 v79, v40, v44
    v_cvt_pk_bf16_f32 v83, v41, v45
    v_cvt_pk_bf16_f32 v87, v42, v46
    v_cvt_pk_bf16_f32 v91, v43, v47
    buffer_load_dwordx4 v[40:43], v1, s[24:27], s50 offen
    buffer_load_dwordx4 v[44:47], v1, s[24:27], s51 offen
    v_fma_mix_f32 v48, v48, v64, v72 op_sel_hi:[1,0,0]
    v_fma_mix_f32 v49, v49, v65, v73 op_sel_hi:[1,0,0]
    v_fma_mix_f32 v50, v50, v66, v74 op_sel_hi:[1,0,0]
    v_fma_mix_f32 v51, v51, v67, v75 op_sel_hi:[1,0,0]
    v_cvt_pk_bf16_f32 v48, v48, v48
    v_cvt_pk_bf16_f32 v49, v49, v49
    v_cvt_pk_bf16_f32 v50, v50, v50
    v_cvt_pk_bf16_f32 v51, v51, v51
L_join2:
    ds_write_b128 v5, v[76:79] offset:36864
    ds_write_b128 v5, v[80:83] offset:37888
    ds_write_b128 v5, v[84:87] offset:38912
    ds_write_b128 v5, v[88:91] offset:39936
    ds_write_b16 v7, v48 offset:36864
    ds_write_b16 v7, v49 offset:36880
    ds_write_b16 v7, v50 offset:36896
    ds_write_b16 v7, v51 offset:36912
    buffer_load_dwordx4 v[48:51], v3, s[24:27], 0 offen
    v_add_u32 v1, 2359296, v1
    v_add_u32 v3, 2359296, v3
    s_waitcnt lgkmcnt(0)
    v_mov_b32 v15, 3
    s_mov_b64 exec, 1
    ds_write_b32 v14, v15
    s_mov_b64 exec, -1
    ds_read_b128 v[60:63], v92 offset:2304
    ds_read_b128 v[68:71], v92 offset:7488
    ds_read_b128 v[64:67], v93 offset:2304
    ds_read_b128 v[72:75], v93 offset:7488
    s_waitcnt vmcnt(0)
    v_or3_b32 v12, v16, v17, v18
    v_or3_b32 v94, v25, v26, v27
    v_or3_b32 v95, v34, v35, v36
    v_or3_b32 v96, v43, v44, v45
    v_or3_b32 v12, v12, v19, v20
    v_or3_b32 v94, v94, v28, v29
    v_or3_b32 v95, v95, v37, v38
    v_or3_b32 v96, v96, v46, v47
    v_or3_b32 v12, v12, v21, v22
    v_or3_b32 v94, v94, v30, v31
    v_or3_b32 v95, v95, v39, v40
    v_or3_b32 v96, v96, v48, v49
    v_or3_b32 v12, v12, v23, v24
    v_or3_b32 v94, v94, v32, v33
    v_or3_b32 v95, v95, v41, v42
    v_or3_b32 v96, v96, v50, v51
    v_or3_b32 v12, v12, v94, v95
    v_or_b32 v12, v12, v96
    v_and_b32 v12, 0xffffff80, v12
    v_cmp_ne_u32 vcc, 0, v12
    s_nop 1
    s_cmp_lg_u64 vcc, 0
    s_cbranch_scc1 L_slow4
    s_cmp_lg_u32 s52, 0
    s_cbranch_scc1 L_slow4
    s_waitcnt lgkmcnt(0)
    v_fma_mix_f32 v16, v16, v60, v68 op_sel_hi:[1,0,0]
    v_fma_mix_f32 v17, v17, v61, v69 op_sel_hi:[1,0,0]
    v_fma_mix_f32 v18, v18, v62, v70 op_sel_hi:[1,0,0]
    v_fma_mix_f32 v19, v19, v63, v71 op_sel_hi:[1,0,0]
    v_fma_mix_f32 v20, v20, v60, v68 op_sel_hi:[1,0,0]
    v_fma_mix_f32 v21, v21, v61, v69 op_sel_hi:[1,0,0]
    v_fma_mix_f32 v22, v22, v62, v70 op_sel_hi:[1,0,0]
    v_fma_mix_f32 v23, v23, v63, v71 op_sel_hi:[1,0,0]
    v_cvt_pk_bf16_f32 v76, v16, v20
    v_cvt_pk_bf16_f32 v80, v17, v21
    v_cvt_pk_bf16_f32 v84, v18, v22
    v_cvt_pk_bf16_f32 v88, v19, v23
    buffer_load_dwordx4 v[16:19], v1, s[24:27], s44 offen
    buffer_load_dwordx4 v[20:23], v1, s[24:27], s45 offen
    v_fma_mix_f32 v24, v24, v60, v68 op_sel_hi:[1,0,0]
    v_fma_mix_f32 v25, v25, v61, v69 op_sel_hi:[1,0,0]
    v_fma_mix_f32 v26, v26, v62, v70 op_sel_hi:[1,0,0]
    v_fma_mix_f32 v27, v27, v63, v71 op_sel_hi:[1,0,0]
    v_fma_mix_f32 v28, v28, v60, v68 op_sel_hi:[1,0,0]
    v_fma_mix_f32 v29, v29, v61, v69 op_sel_hi:[1,0,0]
    v_fma_mix_f32 v30, v30, v62, v70 op_sel_hi:[1,0,0]
    v_fma_mix_f32 v31, v31, v63, v71 op_sel_hi:[1,0,0]
    v_cvt_pk_bf16_f32 v77, v24, v28
    v_cvt_pk_bf16_f32 v81, v25, v29
    v_cvt_pk_bf16_f32 v85, v26, v30
    v_cvt_pk_bf16_f32 v89, v27, v31
    buffer_load_dwordx4 v[24:27], v1, s[24:27], s46 offen
    buffer_load_dwordx4 v[28:31], v1, s[24:27], s47 offen
    v_fma_mix_f32 v32, v32, v60, v68 op_sel_hi:[1,0,0]
    v_fma_mix_f32 v33, v33, v61, v69 op_sel_hi:[1,0,0]
    v_fma_mix_f32 v34, v34, v62, v70 op_sel_hi:[1,0,0]
    v_fma_mix_f32 v35, v35, v63, v71 op_sel_hi:[1,0,0]
    v_fma_mix_f32 v36, v36, v60, v68 op_sel_hi:[1,0,0]
    v_fma_mix_f32 v37, v37, v61, v69 op_sel_hi:[1,0,0]
    v_fma_mix_f32 v38, v38, v62, v70 op_sel_hi:[1,0,0]
    v_fma_mix_f32 v39, v39, v63, v71 op_sel_hi:[1,0,0]
    v_cvt_pk_bf16_f32 v78, v32, v36
    v_cvt_pk_bf16_f32 v82, v33, v37
    v_cvt_pk_bf16_f32 v86, v34, v38
    v_cvt_pk_bf16_f32 v90, v35, v39
    buffer_load_dwordx4 v[32:35], v1, s[24:27], s48 offen
    buffer_load_dwordx4 v[36:39], v1, s[24:27], s49 offen
    v_fma_mix_f32 v40, v40, v60, v68 op_sel_hi:[1,0,0]
    v_fma_mix_f32 v41, v41, v61, v69 op_sel_hi:[1,0,0]
    v_fma_mix_f32 v42, v42, v62, v70 op_sel_hi:[1,0,0]
    v_fma_mix_f32 v43, v43, v63, v71 op_sel_hi:[1,0,0]
    v_fma_mix_f32 v44, v44, v60, v68 op_sel_hi:[1,0,0]
    v_fma_mix_f32 v45, v45, v61, v69 op_sel_hi:[1,0,0]
    v_fma_mix_f32 v46, v46, v62, v70 op_sel_hi:[1,0,0]
    v_fma_mix_f32 v47, v47, v63, v71 op_sel_hi:[1,0,0]
    v_cvt_pk_bf16_f32 v79, v40, v44
    v_cvt_pk_bf16_f32 v83, v41, v45
    v_cvt_pk_bf16_f32 v87, v42, v46
    v_cvt_pk_bf16_f32 v91, v43, v47
    buffer_load_dwordx4 v[40:43], v1, s[24:27], s50 offen
    buffer_load_dwordx4 v[44:47], v1, s[24:27], s51 offen
    v_fma_mix_f32 v48, v48, v64, v72 op_sel_hi:[1,0,0]
    v_fma_mix_f32 v49, v49, v65, v73 op_sel_hi:[1,0,0]
    v_fma_mix_f32 v50, v50, v66, v74 op_sel_hi:[1,0,0]
    v_fma_mix_f32 v51, v51, v67, v75 op_sel_hi:[1,0,0]
    v_cvt_pk_bf16_f32 v48, v48, v48
    v_cvt_pk_bf16_f32 v49, v49, v49
    v_cvt_pk_bf16_f32 v50, v50, v50
    v_cvt_pk_bf16_f32 v51, v51, v51
L_join4:
L_pw4:
    ds_read_b128 v[100:103], v13 offset:32
    ds_read_b128 v[104:107], v13 offset:48
    s_waitcnt lgkmcnt(0)
    v_min3_u32 v100, v100, v101, v102
    v_min3_u32 v100, v100, v103, v104
    v_min3_u32 v100, v100, v105, v106
    v_min_u32 v100, v100, v107
    s_nop 0
    v_readfirstlane_b32 s16, v100
    s_nop 0
    s_cmp_ge_u32 s16, 1
    s_cbranch_scc1 L_pok4
    s_sleep 1
    s_branch L_pw4
L_pok4:
    ds_write_b128 v5, v[76:79] offset:0
    ds_write_b128 v5, v[80:83] offset:1024
    ds_write_b128 v5, v[84:87] offset:2048
    ds_write_b128 v5, v[88:91] offset:3072
    ds_write_b16 v7, v48 offset:0
    ds_write_b16 v7, v49 offset:16
    ds_write_b16 v7, v50 offset:32
    ds_write_b16 v7, v51 offset:48
    buffer_load_dwordx4 v[48:51], v3, s[24:27], 0 offen
    v_add_u32 v1, 2359296, v1
    v_add_u32 v3, 2359296, v3
    s_waitcnt lgkmcnt(0)
    v_mov_b32 v15, 5
    s_mov_b64 exec, 1
    ds_write_b32 v14, v15
    s_mov_b64 exec, -1
    ds_read_b128 v[60:63], v92 offset:3456
    ds_read_b128 v[68:71], v92 offset:8640
    ds_read_b128 v[64:67], v93 offset:3456
    ds_read_b128 v[72:75], v93 offset:8640
    s_waitcnt vmcnt(0)
    v_or3_b32 v12, v16, v17, v18
    v_or3_b32 v94, v25, v26, v27
    v_or3_b32 v95, v34, v35, v36
    v_or3_b32 v96, v43, v44, v45
    v_or3_b32 v12, v12, v19, v20
    v_or3_b32 v94, v94, v28, v29
    v_or3_b32 v95, v95, v37, v38
    v_or3_b32 v96, v96, v46, v47
    v_or3_b32 v12, v12, v21, v22
    v_or3_b32 v94, v94, v30, v31
    v_or3_b32 v95, v95, v39, v40
    v_or3_b32 v96, v96, v48, v49
    v_or3_b32 v12, v12, v23, v24
    v_or3_b32 v94, v94, v32, v33
    v_or3_b32 v95, v95, v41, v42
    v_or3_b32 v96, v96, v50, v51
    v_or3_b32 v12, v12, v94, v95
    v_or_b32 v12, v12, v96
    v_and_b32 v12, 0xffffff80, v12
    v_cmp_ne_u32 vcc, 0, v12
    s_nop 1
    s_cmp_lg_u64 vcc, 0
    s_cbranch_scc1 L_slow6
    s_cmp_lg_u32 s52, 0
    s_cbranch_scc1 L_slow6
    s_waitcnt lgkmcnt(0)
    v_fma_mix_f32 v16, v16, v60, v68 op_sel_hi:[1,0,0]
    v_fma_mix_f32 v17, v17, v61, v69 op_sel_hi:[1,0,0]
    v_fma_mix_f32 v18, v18, v62, v70 op_sel_hi:[1,0,0]
    v_fma_mix_f32 v19, v19, v63, v71 op_sel_hi:[1,0,0]
    v_fma_mix_f32 v20, v20, v60, v68 op_sel_hi:[1,0,0]
    v_fma_mix_f32 v21, v21, v61, v69 op_sel_hi:[1,0,0]
    v_fma_mix_f32 v22, v22, v62, v70 op_sel_hi:[1,0,0]
    v_fma_mix_f32 v23, v23, v63, v71 op_sel_hi:[1,0,0]
    v_cvt_pk_bf16_f32 v76, v16, v20
    v_cvt_pk_bf16_f32 v80, v17, v21
    v_cvt_pk_bf16_f32 v84, v18, v22
    v_cvt_pk_bf16_f32 v88, v19, v23
    buffer_load_dwordx4 v[16:19], v1, s[24:27], s44 offen
    buffer_load_dwordx4 v[20:23], v1, s[24:27], s45 offen
    v_fma_mix_f32 v24, v24, v60, v68 op_sel_hi:[1,0,0]
    v_fma_mix_f32 v25, v25, v61, v69 op_sel_hi:[1,0,0]
    v_fma_mix_f32 v26, v26, v62, v70 op_sel_hi:[1,0,0]
    v_fma_mix_f32 v27, v27, v63, v71 op_sel_hi:[1,0,0]
    v_fma_mix_f32 v28, v28, v60, v68 op_sel_hi:[1,0,0]
    v_fma_mix_f32 v29, v29, v61, v69 op_sel_hi:[1,0,0]
    v_fma_mix_f32 v30, v30, v62, v70 op_sel_hi:[1,0,0]
    v_fma_mix_f32 v31, v31, v63, v71 op_sel_hi:[1,0,0]
    v_cvt_pk_bf16_f32 v77, v24, v28
    v_cvt_pk_bf16_f32 v81, v25, v29
    v_cvt_pk_bf16_f32 v85, v26, v30
    v_cvt_pk_bf16_f32 v89, v27, v31
    buffer_load_dwordx4 v[24:27], v1, s[24:27], s46 offen
    buffer_load_dwordx4 v[28:31], v1, s[24:27], s47 offen
    v_fma_mix_f32 v32, v32, v60, v68 op_sel_hi:[1,0,0]
    v_fma_mix_f32 v33, v33, v61, v69 op_sel_hi:[1,0,0]
    v_fma_mix_f32 v34, v34, v62, v70 op_sel_hi:[1,0,0]
    v_fma_mix_f32 v35, v35, v63, v71 op_sel_hi:[1,0,0]
    v_fma_mix_f32 v36, v36, v60, v68 op_sel_hi:[1,0,0]
    v_fma_mix_f32 v37, v37, v61, v69 op_sel_hi:[1,0,0]
    v_fma_mix_f32 v38, v38, v62, v70 op_sel_hi:[1,0,0]
    v_fma_mix_f32 v39, v39, v63, v71 op_sel_hi:[1,0,0]
    v_cvt_pk_bf16_f32 v78, v32, v36
    v_cvt_pk_bf16_f32 v82, v33, v37
    v_cvt_pk_bf16_f32 v86, v34, v38
    v_cvt_pk_bf16_f32 v90, v35, v39
    buffer_load_dwordx4 v[32:35], v1, s[24:27], s48 offen
    buffer_load_dwordx4 v[36:39], v1, s[24:27], s49 offen
    v_fma_mix_f32 v40, v40, v60, v68 op_sel_hi:[1,0,0]
    v_fma_mix_f32 v41, v41, v61, v69 op_sel_hi:[1,0,0]
    v_fma_mix_f32 v42, v42, v62, v70 op_sel_hi:[1,0,0]
    v_fma_mix_f32 v43, v43, v63, v71 op_sel_hi:[1,0,0]
    v_fma_mix_f32 v44, v44, v60, v68 op_sel_hi:[1,0,0]
    v_fma_mix_f32 v45, v45, v61, v69 op_sel_hi:[1,0,0]
    v_fma_mix_f32 v46, v46, v62, v70 op_sel_hi:[1,0,0]
    v_fma_mix_f32 v47, v47, v63, v71 op_sel_hi:[1,0,0]
    v_cvt_pk_bf16_f32 v79, v40, v44
    v_cvt_pk_bf16_f32 v83, v41, v45
    v_cvt_pk_bf16_f32 v87, v42, v46
    v_cvt_pk_bf16_f32 v91, v43, v47
    buffer_load_dwordx4 v[40:43], v1, s[24:27], s50 offen
    buffer_load_dwordx4 v[44:47], v1, s[24:27], s51 offen
    v_fma_mix_f32 v48, v48, v64, v72 op_sel_hi:[1,0,0]
    v_fma_mix_f32 v49, v49, v65, v73 op_sel_hi:[1,0,0]
    v_fma_mix_f32 v50, v50, v66, v74 op_sel_hi:[1,0,0]
    v_fma_mix_f32 v51, v51, v67, v75 op_sel_hi:[1,0,0]
    v_cvt_pk_bf16_f32 v48, v48, v48
    v_cvt_pk_bf16_f32 v49, v49, v49
    v_cvt_pk_bf16_f32 v50, v50, v50
    v_cvt_pk_bf16_f32 v51, v51, v51
L_join6:
L_pw6:
    ds_read_b128 v[100:103], v13 offset:32
    ds_read_b128 v[104:107], v13 offset:48
    s_waitcnt lgkmcnt(0)
    v_min3_u32 v100, v100, v101, v102
    v_min3_u32 v100, v100, v103, v104
    v_min3_u32 v100, v100, v105, v106
    v_min_u32 v100, v100, v107
    s_nop 0
    v_readfirstlane_b32 s16, v100
    s_nop 0
    s_cmp_ge_u32 s16, 3
    s_cbranch_scc1 L_pok6
    s_sleep 1
    s_branch L_pw6
L_pok6:
    ds_write_b128 v5, v[76:79] offset:36864
    ds_write_b128 v5, v[80:83] offset:37888
    ds_write_b128 v5, v[84:87] offset:38912
    ds_write_b128 v5, v[88:91] offset:39936
    ds_write_b16 v7, v48 offset:36864
    ds_write_b16 v7, v49 offset:36880
    ds_write_b16 v7, v50 offset:36896
    ds_write_b16 v7, v51 offset:36912
    buffer_load_dwordx4 v[48:51], v3, s[24:27], 0 offen
    v_add_u32 v1, 2359296, v1
    v_add_u32 v3, 2359296, v3
    s_waitcnt lgkmcnt(0)
    v_mov_b32 v15, 7
    s_mov_b64 exec, 1
    ds_write_b32 v14, v15
    s_mov_b64 exec, -1
    ds_read_b128 v[60:63], v92 offset:4608
    ds_read_b128 v[68:71], v92 offset:9792
    ds_read_b128 v[64:67], v93 offset:4608
    ds_read_b128 v[72:75], v93 offset:9792
    s_waitcnt vmcnt(0)
    v_or3_b32 v12, v16, v17, v18
    v_or3_b32 v94, v25, v26, v27
    v_or3_b32 v95, v34, v35, v36
    v_or3_b32 v96, v43, v44, v45
    v_or3_b32 v12, v12, v19, v20
    v_or3_b32 v94, v94, v28, v29
    v_or3_b32 v95, v95, v37, v38
    v_or3_b32 v96, v96, v46, v47
    v_or3_b32 v12, v12, v21, v22
    v_or3_b32 v94, v94, v30, v31
    v_or3_b32 v95, v95, v39, v40
    v_or3_b32 v96, v96, v48, v49
    v_or3_b32 v12, v12, v23, v24
    v_or3_b32 v94, v94, v32, v33
    v_or3_b32 v95, v95, v41, v42
    v_or3_b32 v96, v96, v50, v51
    v_or3_b32 v12, v12, v94, v95
    v_or_b32 v12, v12, v96
    v_and_b32 v12, 0xffffff80, v12
    v_cmp_ne_u32 vcc, 0, v12
    s_nop 1
    s_cmp_lg_u64 vcc, 0
    s_cbranch_scc1 L_slow8
    s_cmp_lg_u32 s52, 0
    s_cbranch_scc1 L_slow8
    s_waitcnt lgkmcnt(0)
    v_fma_mix_f32 v16, v16, v60, v68 op_sel_hi:[1,0,0]
    v_fma_mix_f32 v17, v17, v61, v69 op_sel_hi:[1,0,0]
    v_fma_mix_f32 v18, v18, v62, v70 op_sel_hi:[1,0,0]
    v_fma_mix_f32 v19, v19, v63, v71 op_sel_hi:[1,0,0]
    v_fma_mix_f32 v20, v20, v60, v68 op_sel_hi:[1,0,0]
    v_fma_mix_f32 v21, v21, v61, v69 op_sel_hi:[1,0,0]
    v_fma_mix_f32 v22, v22, v62, v70 op_sel_hi:[1,0,0]
    v_fma_mix_f32 v23, v23, v63, v71 op_sel_hi:[1,0,0]
    v_cvt_pk_bf16_f32 v76, v16, v20
    v_cvt_pk_bf16_f32 v80, v17, v21
    v_cvt_pk_bf16_f32 v84, v18, v22
    v_cvt_pk_bf16_f32 v88, v19, v23
    v_fma_mix_f32 v24, v24, v60, v68 op_sel_hi:[1,0,0]
    v_fma_mix_f32 v25, v25, v61, v69 op_sel_hi:[1,0,0]
    v_fma_mix_f32 v26, v26, v62, v70 op_sel_hi:[1,0,0]
    v_fma_mix_f32 v27, v27, v63, v71 op_sel_hi:[1,0,0]
    v_fma_mix_f32 v28, v28, v60, v68 op_sel_hi:[1,0,0]
    v_fma_mix_f32 v29, v29, v61, v69 op_sel_hi:[1,0,0]
    v_fma_mix_f32 v30, v30, v62, v70 op_sel_hi:[1,0,0]
    v_fma_mix_f32 v31, v31, v63, v71 op_sel_hi:[1,0,0]
    v_cvt_pk_bf16_f32 v77, v24, v28
    v_cvt_pk_bf16_f32 v81, v25, v29
    v_cvt_pk_bf16_f32 v85, v26, v30
    v_cvt_pk_bf16_f32 v89, v27, v31
    v_fma_mix_f32 v32, v32, v60, v68 op_sel_hi:[1,0,0]
    v_fma_mix_f32 v33, v33, v61, v69 op_sel_hi:[1,0,0]
    v_fma_mix_f32 v34, v34, v62, v70 op_sel_hi:[1,0,0]
    v_fma_mix_f32 v35, v35, v63, v71 op_sel_hi:[1,0,0]
    v_fma_mix_f32 v36, v36, v60, v68 op_sel_hi:[1,0,0]
    v_fma_mix_f32 v37, v37, v61, v69 op_sel_hi:[1,0,0]
    v_fma_mix_f32 v38, v38, v62, v70 op_sel_hi:[1,0,0]
    v_fma_mix_f32 v39, v39, v63, v71 op_sel_hi:[1,0,0]
    v_cvt_pk_bf16_f32 v78, v32, v36
    v_cvt_pk_bf16_f32 v82, v33, v37
    v_cvt_pk_bf16_f32 v86, v34, v38
    v_cvt_pk_bf16_f32 v90, v35, v39
    v_fma_mix_f32 v40, v40, v60, v68 op_sel_hi:[1,0,0]
    v_fma_mix_f32 v41, v41, v61, v69 op_sel_hi:[1,0,0]
    v_fma_mix_f32 v42, v42, v62, v70 op_sel_hi:[1,0,0]
    v_fma_mix_f32 v43, v43, v63, v71 op_sel_hi:[1,0,0]
    v_fma_mix_f32 v44, v44, v60, v68 op_sel_hi:[1,0,0]
    v_fma_mix_f32 v45, v45, v61, v69 op_sel_hi:[1,0,0]
    v_fma_mix_f32 v46, v46, v62, v70 op_sel_hi:[1,0,0]
    v_fma_mix_f32 v47, v47, v63, v71 op_sel_hi:[1,0,0]
    v_cvt_pk_bf16_f32 v79, v40, v44
    v_cvt_pk_bf16_f32 v83, v41, v45
    v_cvt_pk_bf16_f32 v87, v42, v46
    v_cvt_pk_bf16_f32 v91, v43, v47
    v_fma_mix_f32 v48, v48, v64, v72 op_sel_hi:[1,0,0]
    v_fma_mix_f32 v49, v49, v65, v73 op_sel_hi:[1,0,0]
    v_fma_mix_f32 v50, v50, v66, v74 op_sel_hi:[1,0,0]
    v_fma_mix_f32 v51, v51, v67, v75 op_sel_hi:[1,0,0]
    v_cvt_pk_bf16_f32 v48, v48, v48
    v_cvt_pk_bf16_f32 v49, v49, v49
    v_cvt_pk_bf16_f32 v50, v50, v50
    v_cvt_pk_bf16_f32 v51, v51, v51
L_join8:
L_pw8:
    ds_read_b128 v[100:103], v13 offset:32
    ds_read_b128 v[104:107], v13 offset:48
    s_waitcnt lgkmcnt(0)
    v_min3_u32 v100, v100, v101, v102
    v_min3_u32 v100, v100, v103, v104
    v_min3_u32 v100, v100, v105, v106
    v_min_u32 v100, v100, v107
    s_nop 0
    v_readfirstlane_b32 s16, v100
    s_nop 0
    s_cmp_ge_u32 s16, 5
    s_cbranch_scc1 L_pok8
    s_sleep 1
    s_branch L_pw8
L_pok8:
    ds_write_b128 v5, v[76:79] offset:0
    ds_write_b128 v5, v[80:83] offset:1024
    ds_write_b128 v5, v[84:87] offset:2048
    ds_write_b128 v5, v[88:91] offset:3072
    ds_write_b16 v7, v48 offset:0
    ds_write_b16 v7, v49 offset:16
    ds_write_b16 v7, v50 offset:32
    ds_write_b16 v7, v51 offset:48
    s_waitcnt lgkmcnt(0)
    v_mov_b32 v15, 9
    s_mov_b64 exec, 1
    ds_write_b32 v14, v15
    s_mov_b64 exec, -1
    s_endpgm
L_prod1:
    v_add_u32 v9, -768, v0
    s_mov_b32 s44, 0
    s_mov_b32 s45, 18432
    s_mov_b32 s46, 36864
    s_mov_b32 s47, 55296
    s_mov_b32 s48, 73728
    s_mov_b32 s49, 92160
    s_mov_b32 s50, 110592
    s_mov_b32 s51, 129024
    v_lshrrev_b32 v10, 5, v9
    v_and_b32 v11, 31, v9
    v_mul_u32_u24 v1, 147456, v10
    v_lshl_add_u32 v1, v11, 4, v1
    v_add_u32 v1, s54, v1
    v_add_u32 v1, 1179648, v1
    v_lshlrev_b32 v2, 3, v11
    v_add_u32 v2, s55, v2
    v_lshlrev_b32 v92, 4, v11
    v_add_u32 v92, 139264, v92
    v_lshrrev_b32 v12, 2, v10
    v_mul_u32_u24 v5, 9216, v12
    v_and_b32 v12, 3, v10
    v_lshl_add_u32 v5, v12, 8, v5
    v_and_b32 v12, 1, v11
    v_lshl_add_u32 v5, v12, 12, v5
    v_lshlrev_b32 v12, 2, v12
    v_lshrrev_b32 v11, 1, v11
    v_xor_b32 v12, v12, v11
    v_lshl_add_u32 v5, v12, 4, v5
    v_add_u32 v6, 65536, v5
    v_lshrrev_b32 v10, 2, v9
    v_and_b32 v11, 3, v9
    v_mul_u32_u24 v3, 18432, v10
    v_lshl_add_u32 v3, v11, 4, v3
    v_add_u32 v3, s54, v3
    v_add_u32 v3, 1180160, v3
    v_lshlrev_b32 v4, 3, v11
    v_add_u32 v4, s55, v4
    v_add_u32 v4, 256, v4
    v_lshlrev_b32 v93, 4, v11
    v_add_u32 v93, 139776, v93
    v_lshrrev_b32 v12, 5, v10
    v_mul_u32_u24 v7, 9216, v12
    v_bfe_u32 v12, v10, 3, 2
    v_lshl_add_u32 v7, v12, 8, v7
    v_lshl_add_u32 v7, v11, 6, v7
    v_and_b32 v12, 7, v10
    v_lshl_add_u32 v7, v12, 1, v7
    v_add_u32 v7, 8192, v7
    v_add_u32 v8, 65536, v7
    v_mov_b32 v13, 149632
    s_lshl_b32 s17, s56, 2
    s_add_u32 s17, s17, 149600
    v_mov_b32 v14, s17
    v_mov_b32 v15, 0
    ds_write_b32 v14, v15
    buffer_load_dwordx4 v[16:19], v1, s[24:27], s44 offen
    buffer_load_dwordx4 v[20:23], v1, s[24:27], s45 offen
    buffer_load_dwordx4 v[24:27], v1, s[24:27], s46 offen
    buffer_load_dwordx4 v[28:31], v1, s[24:27], s47 offen
    buffer_load_dwordx4 v[32:35], v1, s[24:27], s48 offen
    buffer_load_dwordx4 v[36:39], v1, s[24:27], s49 offen
    buffer_load_dwordx4 v[40:43], v1, s[24:27], s50 offen
    buffer_load_dwordx4 v[44:47], v1, s[24:27], s51 offen
    buffer_load_dwordx4 v[48:51], v3, s[24:27], 0 offen
    v_add_u32 v1, 2359296, v1
    v_add_u32 v3, 2359296, v3
    s_waitcnt lgkmcnt(0)
    s_barrier
    ds_read_b128 v[100:103], v13 offset:64
    ds_read_b128 v[104:107], v13 offset:80
    s_waitcnt lgkmcnt(0)
    v_or3_b32 v100, v100, v101, v102
    v_or3_b32 v100, v100, v103, v104
    v_or3_b32 v100, v100, v105, v106
    v_or_b32 v100, v100, v107
    s_nop 0
    v_readfirstlane_b32 s52, v100
    ds_read_b128 v[60:63], v92 offset:576
    ds_read_b128 v[68:71], v92 offset:5760
    ds_read_b128 v[64:67], v93 offset:576
    ds_read_b128 v[72:75], v93 offset:5760
    s_waitcnt vmcnt(0)
    v_or3_b32 v12, v16, v17, v18
    v_or3_b32 v94, v25, v26, v27
    v_or3_b32 v95, v34, v35, v36
    v_or3_b32 v96, v43, v44, v45
    v_or3_b32 v12, v12, v19, v20
    v_or3_b32 v94, v94, v28, v29
    v_or3_b32 v95, v95, v37, v38
    v_or3_b32 v96, v96, v46, v47
    v_or3_b32 v12, v12, v21, v22
    v_or3_b32 v94, v94, v30, v31
    v_or3_b32 v95, v95, v39, v40
    v_or3_b32 v96, v96, v48, v49
    v_or3_b32 v12, v12, v23, v24
    v_or3_b32 v94, v94, v32, v33
    v_or3_b32 v95, v95, v41, v42
    v_or3_b32 v96, v96, v50, v51
    v_or3_b32 v12, v12, v94, v95
    v_or_b32 v12, v12, v96
    v_and_b32 v12, 0xffffff80, v12
    v_cmp_ne_u32 vcc, 0, v12
    s_nop 1
    s_cmp_lg_u64 vcc, 0
    s_cbranch_scc1 L_slow1
    s_cmp_lg_u32 s52, 0
    s_cbranch_scc1 L_slow1
    s_waitcnt lgkmcnt(0)
    v_fma_mix_f32 v16, v16, v60, v68 op_sel_hi:[1,0,0]
    v_fma_mix_f32 v17, v17, v61, v69 op_sel_hi:[1,0,0]
    v_fma_mix_f32 v18, v18, v62, v70 op_sel_hi:[1,0,0]
    v_fma_mix_f32 v19, v19, v63, v71 op_sel_hi:[1,0,0]
    v_fma_mix_f32 v20, v20, v60, v68 op_sel_hi:[1,0,0]
    v_fma_mix_f32 v21, v21, v61, v69 op_sel_hi:[1,0,0]
    v_fma_mix_f32 v22, v22, v62, v70 op_sel_hi:[1,0,0]
    v_fma_mix_f32 v23, v23, v63, v71 op_sel_hi:[1,0,0]
    v_cvt_pk_bf16_f32 v76, v16, v20
    v_cvt_pk_bf16_f32 v80, v17, v21
    v_cvt_pk_bf16_f32 v84, v18, v22
    v_cvt_pk_bf16_f32 v88, v19, v23
    buffer_load_dwordx4 v[16:19], v1, s[24:27], s44 offen
    buffer_load_dwordx4 v[20:23], v1, s[24:27], s45 offen
    v_fma_mix_f32 v24, v24, v60, v68 op_sel_hi:[1,0,0]
    v_fma_mix_f32 v25, v25, v61, v69 op_sel_hi:[1,0,0]
    v_fma_mix_f32 v26, v26, v62, v70 op_sel_hi:[1,0,0]
    v_fma_mix_f32 v27, v27, v63, v71 op_sel_hi:[1,0,0]
    v_fma_mix_f32 v28, v28, v60, v68 op_sel_hi:[1,0,0]
    v_fma_mix_f32 v29, v29, v61, v69 op_sel_hi:[1,0,0]
    v_fma_mix_f32 v30, v30, v62, v70 op_sel_hi:[1,0,0]
    v_fma_mix_f32 v31, v31, v63, v71 op_sel_hi:[1,0,0]
    v_cvt_pk_bf16_f32 v77, v24, v28
    v_cvt_pk_bf16_f32 v81, v25, v29
    v_cvt_pk_bf16_f32 v85, v26, v30
    v_cvt_pk_bf16_f32 v89, v27, v31
    buffer_load_dwordx4 v[24:27], v1, s[24:27], s46 offen
    buffer_load_dwordx4 v[28:31], v1, s[24:27], s47 offen
    v_fma_mix_f32 v32, v32, v60, v68 op_sel_hi:[1,0,0]
    v_fma_mix_f32 v33, v33, v61, v69 op_sel_hi:[1,0,0]
    v_fma_mix_f32 v34, v34, v62, v70 op_sel_hi:[1,0,0]
    v_fma_mix_f32 v35, v35, v63, v71 op_sel_hi:[1,0,0]
    v_fma_mix_f32 v36, v36, v60, v68 op_sel_hi:[1,0,0]
    v_fma_mix_f32 v37, v37, v61, v69 op_sel_hi:[1,0,0]
    v_fma_mix_f32 v38, v38, v62, v70 op_sel_hi:[1,0,0]
    v_fma_mix_f32 v39, v39, v63, v71 op_sel_hi:[1,0,0]
    v_cvt_pk_bf16_f32 v78, v32, v36
    v_cvt_pk_bf16_f32 v82, v33, v37
    v_cvt_pk_bf16_f32 v86, v34, v38
    v_cvt_pk_bf16_f32 v90, v35, v39
    buffer_load_dwordx4 v[32:35], v1, s[24:27], s48 offen
    buffer_load_dwordx4 v[36:39], v1, s[24:27], s49 offen
    v_fma_mix_f32 v40, v40, v60, v68 op_sel_hi:[1,0,0]
    v_fma_mix_f32 v41, v41, v61, v69 op_sel_hi:[1,0,0]
    v_fma_mix_f32 v42, v42, v62, v70 op_sel_hi:[1,0,0]
    v_fma_mix_f32 v43, v43, v63, v71 op_sel_hi:[1,0,0]
    v_fma_mix_f32 v44, v44, v60, v68 op_sel_hi:[1,0,0]
    v_fma_mix_f32 v45, v45, v61, v69 op_sel_hi:[1,0,0]
    v_fma_mix_f32 v46, v46, v62, v70 op_sel_hi:[1,0,0]
    v_fma_mix_f32 v47, v47, v63, v71 op_sel_hi:[1,0,0]
    v_cvt_pk_bf16_f32 v79, v40, v44
    v_cvt_pk_bf16_f32 v83, v41, v45
    v_cvt_pk_bf16_f32 v87, v42, v46
    v_cvt_pk_bf16_f32 v91, v43, v47
    buffer_load_dwordx4 v[40:43], v1, s[24:27], s50 offen
    buffer_load_dwordx4 v[44:47], v1, s[24:27], s51 offen
    v_fma_mix_f32 v48, v48, v64, v72 op_sel_hi:[1,0,0]
    v_fma_mix_f32 v49, v49, v65, v73 op_sel_hi:[1,0,0]
    v_fma_mix_f32 v50, v50, v66, v74 op_sel_hi:[1,0,0]
    v_fma_mix_f32 v51, v51, v67, v75 op_sel_hi:[1,0,0]
    v_cvt_pk_bf16_f32 v48, v48, v48
    v_cvt_pk_bf16_f32 v49, v49, v49
    v_cvt_pk_bf16_f32 v50, v50, v50
    v_cvt_pk_bf16_f32 v51, v51, v51
L_join1:
    ds_write_b128 v5, v[76:79] offset:18432
    ds_write_b128 v5, v[80:83] offset:19456
    ds_write_b128 v5, v[84:87] offset:20480
    ds_write_b128 v5, v[88:91] offset:21504
    ds_write_b16 v7, v48 offset:18432
    ds_write_b16 v7, v49 offset:18448
    ds_write_b16 v7, v50 offset:18464
    ds_write_b16 v7, v51 offset:18480
    buffer_load_dwordx4 v[48:51], v3, s[24:27], 0 offen
    v_add_u32 v1, 2359296, v1
    v_add_u32 v3, 2359296, v3
    s_waitcnt lgkmcnt(0)
    v_mov_b32 v15, 2
    s_mov_b64 exec, 1
    ds_write_b32 v14, v15
    s_mov_b64 exec, -1
    ds_read_b128 v[60:63], v92 offset:1728
    ds_read_b128 v[68:71], v92 offset:6912
    ds_read_b128 v[64:67], v93 offset:1728
    ds_read_b128 v[72:75], v93 offset:6912
    s_waitcnt vmcnt(0)
    v_or3_b32 v12, v16, v17, v18
    v_or3_b32 v94, v25, v26, v27
    v_or3_b32 v95, v34, v35, v36
    v_or3_b32 v96, v43, v44, v45
    v_or3_b32 v12, v12, v19, v20
    v_or3_b32 v94, v94, v28, v29
    v_or3_b32 v95, v95, v37, v38
    v_or3_b32 v96, v96, v46, v47
    v_or3_b32 v12, v12, v21, v22
    v_or3_b32 v94, v94, v30, v31
    v_or3_b32 v95, v95, v39, v40
    v_or3_b32 v96, v96, v48, v49
    v_or3_b32 v12, v12, v23, v24
    v_or3_b32 v94, v94, v32, v33
    v_or3_b32 v95, v95, v41, v42
    v_or3_b32 v96, v96, v50, v51
    v_or3_b32 v12, v12, v94, v95
    v_or_b32 v12, v12, v96
    v_and_b32 v12, 0xffffff80, v12
    v_cmp_ne_u32 vcc, 0, v12
    s_nop 1
    s_cmp_lg_u64 vcc, 0
    s_cbranch_scc1 L_slow3
    s_cmp_lg_u32 s52, 0
    s_cbranch_scc1 L_slow3
    s_waitcnt lgkmcnt(0)
    v_fma_mix_f32 v16, v16, v60, v68 op_sel_hi:[1,0,0]
    v_fma_mix_f32 v17, v17, v61, v69 op_sel_hi:[1,0,0]
    v_fma_mix_f32 v18, v18, v62, v70 op_sel_hi:[1,0,0]
    v_fma_mix_f32 v19, v19, v63, v71 op_sel_hi:[1,0,0]
    v_fma_mix_f32 v20, v20, v60, v68 op_sel_hi:[1,0,0]
    v_fma_mix_f32 v21, v21, v61, v69 op_sel_hi:[1,0,0]
    v_fma_mix_f32 v22, v22, v62, v70 op_sel_hi:[1,0,0]
    v_fma_mix_f32 v23, v23, v63, v71 op_sel_hi:[1,0,0]
    v_cvt_pk_bf16_f32 v76, v16, v20
    v_cvt_pk_bf16_f32 v80, v17, v21
    v_cvt_pk_bf16_f32 v84, v18, v22
    v_cvt_pk_bf16_f32 v88, v19, v23
    buffer_load_dwordx4 v[16:19], v1, s[24:27], s44 offen
    buffer_load_dwordx4 v[20:23], v1, s[24:27], s45 offen
    v_fma_mix_f32 v24, v24, v60, v68 op_sel_hi:[1,0,0]
    v_fma_mix_f32 v25, v25, v61, v69 op_sel_hi:[1,0,0]
    v_fma_mix_f32 v26, v26, v62, v70 op_sel_hi:[1,0,0]
    v_fma_mix_f32 v27, v27, v63, v71 op_sel_hi:[1,0,0]
    v_fma_mix_f32 v28, v28, v60, v68 op_sel_hi:[1,0,0]
    v_fma_mix_f32 v29, v29, v61, v69 op_sel_hi:[1,0,0]
    v_fma_mix_f32 v30, v30, v62, v70 op_sel_hi:[1,0,0]
    v_fma_mix_f32 v31, v31, v63, v71 op_sel_hi:[1,0,0]
    v_cvt_pk_bf16_f32 v77, v24, v28
    v_cvt_pk_bf16_f32 v81, v25, v29
    v_cvt_pk_bf16_f32 v85, v26, v30
    v_cvt_pk_bf16_f32 v89, v27, v31
    buffer_load_dwordx4 v[24:27], v1, s[24:27], s46 offen
    buffer_load_dwordx4 v[28:31], v1, s[24:27], s47 offen
    v_fma_mix_f32 v32, v32, v60, v68 op_sel_hi:[1,0,0]
    v_fma_mix_f32 v33, v33, v61, v69 op_sel_hi:[1,0,0]
    v_fma_mix_f32 v34, v34, v62, v70 op_sel_hi:[1,0,0]
    v_fma_mix_f32 v35, v35, v63, v71 op_sel_hi:[1,0,0]
    v_fma_mix_f32 v36, v36, v60, v68 op_sel_hi:[1,0,0]
    v_fma_mix_f32 v37, v37, v61, v69 op_sel_hi:[1,0,0]
    v_fma_mix_f32 v38, v38, v62, v70 op_sel_hi:[1,0,0]
    v_fma_mix_f32 v39, v39, v63, v71 op_sel_hi:[1,0,0]
    v_cvt_pk_bf16_f32 v78, v32, v36
    v_cvt_pk_bf16_f32 v82, v33, v37
    v_cvt_pk_bf16_f32 v86, v34, v38
    v_cvt_pk_bf16_f32 v90, v35, v39
    buffer_load_dwordx4 v[32:35], v1, s[24:27], s48 offen
    buffer_load_dwordx4 v[36:39], v1, s[24:27], s49 offen
    v_fma_mix_f32 v40, v40, v60, v68 op_sel_hi:[1,0,0]
    v_fma_mix_f32 v41, v41, v61, v69 op_sel_hi:[1,0,0]
    v_fma_mix_f32 v42, v42, v62, v70 op_sel_hi:[1,0,0]
    v_fma_mix_f32 v43, v43, v63, v71 op_sel_hi:[1,0,0]
    v_fma_mix_f32 v44, v44, v60, v68 op_sel_hi:[1,0,0]
    v_fma_mix_f32 v45, v45, v61, v69 op_sel_hi:[1,0,0]
    v_fma_mix_f32 v46, v46, v62, v70 op_sel_hi:[1,0,0]
    v_fma_mix_f32 v47, v47, v63, v71 op_sel_hi:[1,0,0]
    v_cvt_pk_bf16_f32 v79, v40, v44
    v_cvt_pk_bf16_f32 v83, v41, v45
    v_cvt_pk_bf16_f32 v87, v42, v46
    v_cvt_pk_bf16_f32 v91, v43, v47
    buffer_load_dwordx4 v[40:43], v1, s[24:27], s50 offen
    buffer_load_dwordx4 v[44:47], v1, s[24:27], s51 offen
    v_fma_mix_f32 v48, v48, v64, v72 op_sel_hi:[1,0,0]
    v_fma_mix_f32 v49, v49, v65, v73 op_sel_hi:[1,0,0]
    v_fma_mix_f32 v50, v50, v66, v74 op_sel_hi:[1,0,0]
    v_fma_mix_f32 v51, v51, v67, v75 op_sel_hi:[1,0,0]
    v_cvt_pk_bf16_f32 v48, v48, v48
    v_cvt_pk_bf16_f32 v49, v49, v49
    v_cvt_pk_bf16_f32 v50, v50, v50
    v_cvt_pk_bf16_f32 v51, v51, v51
L_join3:
    ds_write_b128 v5, v[76:79] offset:55296
    ds_write_b128 v5, v[80:83] offset:56320
    ds_write_b128 v5, v[84:87] offset:57344
    ds_write_b128 v5, v[88:91] offset:58368
    ds_write_b16 v7, v48 offset:55296
    ds_write_b16 v7, v49 offset:55312
    ds_write_b16 v7, v50 offset:55328
    ds_write_b16 v7, v51 offset:55344
    buffer_load_dwordx4 v[48:51], v3, s[24:27], 0 offen
    v_add_u32 v1, 2359296, v1
    v_add_u32 v3, 2359296, v3
    s_waitcnt lgkmcnt(0)
    v_mov_b32 v15, 4
    s_mov_b64 exec, 1
    ds_write_b32 v14, v15
    s_mov_b64 exec, -1
    ds_read_b128 v[60:63], v92 offset:2880
    ds_read_b128 v[68:71], v92 offset:8064
    ds_read_b128 v[64:67], v93 offset:2880
    ds_read_b128 v[72:75], v93 offset:8064
    s_waitcnt vmcnt(0)
    v_or3_b32 v12, v16, v17, v18
    v_or3_b32 v94, v25, v26, v27
    v_or3_b32 v95, v34, v35, v36
    v_or3_b32 v96, v43, v44, v45
    v_or3_b32 v12, v12, v19, v20
    v_or3_b32 v94, v94, v28, v29
    v_or3_b32 v95, v95, v37, v38
    v_or3_b32 v96, v96, v46, v47
    v_or3_b32 v12, v12, v21, v22
    v_or3_b32 v94, v94, v30, v31
    v_or3_b32 v95, v95, v39, v40
    v_or3_b32 v96, v96, v48, v49
    v_or3_b32 v12, v12, v23, v24
    v_or3_b32 v94, v94, v32, v33
    v_or3_b32 v95, v95, v41, v42
    v_or3_b32 v96, v96, v50, v51
    v_or3_b32 v12, v12, v94, v95
    v_or_b32 v12, v12, v96
    v_and_b32 v12, 0xffffff80, v12
    v_cmp_ne_u32 vcc, 0, v12
    s_nop 1
    s_cmp_lg_u64 vcc, 0
    s_cbranch_scc1 L_slow5
    s_cmp_lg_u32 s52, 0
    s_cbranch_scc1 L_slow5
    s_waitcnt lgkmcnt(0)
    v_fma_mix_f32 v16, v16, v60, v68 op_sel_hi:[1,0,0]
    v_fma_mix_f32 v17, v17, v61, v69 op_sel_hi:[1,0,0]
    v_fma_mix_f32 v18, v18, v62, v70 op_sel_hi:[1,0,0]
    v_fma_mix_f32 v19, v19, v63, v71 op_sel_hi:[1,0,0]
    v_fma_mix_f32 v20, v20, v60, v68 op_sel_hi:[1,0,0]
    v_fma_mix_f32 v21, v21, v61, v69 op_sel_hi:[1,0,0]
    v_fma_mix_f32 v22, v22, v62, v70 op_sel_hi:[1,0,0]
    v_fma_mix_f32 v23, v23, v63, v71 op_sel_hi:[1,0,0]
    v_cvt_pk_bf16_f32 v76, v16, v20
    v_cvt_pk_bf16_f32 v80, v17, v21
    v_cvt_pk_bf16_f32 v84, v18, v22
    v_cvt_pk_bf16_f32 v88, v19, v23
    buffer_load_dwordx4 v[16:19], v1, s[24:27], s44 offen
    buffer_load_dwordx4 v[20:23], v1, s[24:27], s45 offen
    v_fma_mix_f32 v24, v24, v60, v68 op_sel_hi:[1,0,0]
    v_fma_mix_f32 v25, v25, v61, v69 op_sel_hi:[1,0,0]
    v_fma_mix_f32 v26, v26, v62, v70 op_sel_hi:[1,0,0]
    v_fma_mix_f32 v27, v27, v63, v71 op_sel_hi:[1,0,0]
    v_fma_mix_f32 v28, v28, v60, v68 op_sel_hi:[1,0,0]
    v_fma_mix_f32 v29, v29, v61, v69 op_sel_hi:[1,0,0]
    v_fma_mix_f32 v30, v30, v62, v70 op_sel_hi:[1,0,0]
    v_fma_mix_f32 v31, v31, v63, v71 op_sel_hi:[1,0,0]
    v_cvt_pk_bf16_f32 v77, v24, v28
    v_cvt_pk_bf16_f32 v81, v25, v29
    v_cvt_pk_bf16_f32 v85, v26, v30
    v_cvt_pk_bf16_f32 v89, v27, v31
    buffer_load_dwordx4 v[24:27], v1, s[24:27], s46 offen
    buffer_load_dwordx4 v[28:31], v1, s[24:27], s47 offen
    v_fma_mix_f32 v32, v32, v60, v68 op_sel_hi:[1,0,0]
    v_fma_mix_f32 v33, v33, v61, v69 op_sel_hi:[1,0,0]
    v_fma_mix_f32 v34, v34, v62, v70 op_sel_hi:[1,0,0]
    v_fma_mix_f32 v35, v35, v63, v71 op_sel_hi:[1,0,0]
    v_fma_mix_f32 v36, v36, v60, v68 op_sel_hi:[1,0,0]
    v_fma_mix_f32 v37, v37, v61, v69 op_sel_hi:[1,0,0]
    v_fma_mix_f32 v38, v38, v62, v70 op_sel_hi:[1,0,0]
    v_fma_mix_f32 v39, v39, v63, v71 op_sel_hi:[1,0,0]
    v_cvt_pk_bf16_f32 v78, v32, v36
    v_cvt_pk_bf16_f32 v82, v33, v37
    v_cvt_pk_bf16_f32 v86, v34, v38
    v_cvt_pk_bf16_f32 v90, v35, v39
    buffer_load_dwordx4 v[32:35], v1, s[24:27], s48 offen
    buffer_load_dwordx4 v[36:39], v1, s[24:27], s49 offen
    v_fma_mix_f32 v40, v40, v60, v68 op_sel_hi:[1,0,0]
    v_fma_mix_f32 v41, v41, v61, v69 op_sel_hi:[1,0,0]
    v_fma_mix_f32 v42, v42, v62, v70 op_sel_hi:[1,0,0]
    v_fma_mix_f32 v43, v43, v63, v71 op_sel_hi:[1,0,0]
    v_fma_mix_f32 v44, v44, v60, v68 op_sel_hi:[1,0,0]
    v_fma_mix_f32 v45, v45, v61, v69 op_sel_hi:[1,0,0]
    v_fma_mix_f32 v46, v46, v62, v70 op_sel_hi:[1,0,0]
    v_fma_mix_f32 v47, v47, v63, v71 op_sel_hi:[1,0,0]
    v_cvt_pk_bf16_f32 v79, v40, v44
    v_cvt_pk_bf16_f32 v83, v41, v45
    v_cvt_pk_bf16_f32 v87, v42, v46
    v_cvt_pk_bf16_f32 v91, v43, v47
    buffer_load_dwordx4 v[40:43], v1, s[24:27], s50 offen
    buffer_load_dwordx4 v[44:47], v1, s[24:27], s51 offen
    v_fma_mix_f32 v48, v48, v64, v72 op_sel_hi:[1,0,0]
    v_fma_mix_f32 v49, v49, v65, v73 op_sel_hi:[1,0,0]
    v_fma_mix_f32 v50, v50, v66, v74 op_sel_hi:[1,0,0]
    v_fma_mix_f32 v51, v51, v67, v75 op_sel_hi:[1,0,0]
    v_cvt_pk_bf16_f32 v48, v48, v48
    v_cvt_pk_bf16_f32 v49, v49, v49
    v_cvt_pk_bf16_f32 v50, v50, v50
    v_cvt_pk_bf16_f32 v51, v51, v51
L_join5:
L_pw5:
    ds_read_b128 v[100:103], v13 offset:32
    ds_read_b128 v[104:107], v13 offset:48
    s_waitcnt lgkmcnt(0)
    v_min3_u32 v100, v100, v101, v102
    v_min3_u32 v100, v100, v103, v104
    v_min3_u32 v100, v100, v105, v106
    v_min_u32 v100, v100, v107
    s_nop 0
    v_readfirstlane_b32 s16, v100
    s_nop 0
    s_cmp_ge_u32 s16, 2
    s_cbranch_scc1 L_pok5
    s_sleep 1
    s_branch L_pw5
L_pok5:
    ds_write_b128 v5, v[76:79] offset:18432
    ds_write_b128 v5, v[80:83] offset:19456
    ds_write_b128 v5, v[84:87] offset:20480
    ds_write_b128 v5, v[88:91] offset:21504
    ds_write_b16 v7, v48 offset:18432
    ds_write_b16 v7, v49 offset:18448
    ds_write_b16 v7, v50 offset:18464
    ds_write_b16 v7, v51 offset:18480
    buffer_load_dwordx4 v[48:51], v3, s[24:27], 0 offen
    v_add_u32 v1, 2359296, v1
    v_add_u32 v3, 2359296, v3
    s_waitcnt lgkmcnt(0)
    v_mov_b32 v15, 6
    s_mov_b64 exec, 1
    ds_write_b32 v14, v15
    s_mov_b64 exec, -1
    ds_read_b128 v[60:63], v92 offset:4032
    ds_read_b128 v[68:71], v92 offset:9216
    ds_read_b128 v[64:67], v93 offset:4032
    ds_read_b128 v[72:75], v93 offset:9216
    s_waitcnt vmcnt(0)
    v_or3_b32 v12, v16, v17, v18
    v_or3_b32 v94, v25, v26, v27
    v_or3_b32 v95, v34, v35, v36
    v_or3_b32 v96, v43, v44, v45
    v_or3_b32 v12, v12, v19, v20
    v_or3_b32 v94, v94, v28, v29
    v_or3_b32 v95, v95, v37, v38
    v_or3_b32 v96, v96, v46, v47
    v_or3_b32 v12, v12, v21, v22
    v_or3_b32 v94, v94, v30, v31
    v_or3_b32 v95, v95, v39, v40
    v_or3_b32 v96, v96, v48, v49
    v_or3_b32 v12, v12, v23, v24
    v_or3_b32 v94, v94, v32, v33
    v_or3_b32 v95, v95, v41, v42
    v_or3_b32 v96, v96, v50, v51
    v_or3_b32 v12, v12, v94, v95
    v_or_b32 v12, v12, v96
    v_and_b32 v12, 0xffffff80, v12
    v_cmp_ne_u32 vcc, 0, v12
    s_nop 1
    s_cmp_lg_u64 vcc, 0
    s_cbranch_scc1 L_slow7
    s_cmp_lg_u32 s52, 0
    s_cbranch_scc1 L_slow7
    s_waitcnt lgkmcnt(0)
    v_fma_mix_f32 v16, v16, v60, v68 op_sel_hi:[1,0,0]
    v_fma_mix_f32 v17, v17, v61, v69 op_sel_hi:[1,0,0]
    v_fma_mix_f32 v18, v18, v62, v70 op_sel_hi:[1,0,0]
    v_fma_mix_f32 v19, v19, v63, v71 op_sel_hi:[1,0,0]
    v_fma_mix_f32 v20, v20, v60, v68 op_sel_hi:[1,0,0]
    v_fma_mix_f32 v21, v21, v61, v69 op_sel_hi:[1,0,0]
    v_fma_mix_f32 v22, v22, v62, v70 op_sel_hi:[1,0,0]
    v_fma_mix_f32 v23, v23, v63, v71 op_sel_hi:[1,0,0]
    v_cvt_pk_bf16_f32 v76, v16, v20
    v_cvt_pk_bf16_f32 v80, v17, v21
    v_cvt_pk_bf16_f32 v84, v18, v22
    v_cvt_pk_bf16_f32 v88, v19, v23
    v_fma_mix_f32 v24, v24, v60, v68 op_sel_hi:[1,0,0]
    v_fma_mix_f32 v25, v25, v61, v69 op_sel_hi:[1,0,0]
    v_fma_mix_f32 v26, v26, v62, v70 op_sel_hi:[1,0,0]
    v_fma_mix_f32 v27, v27, v63, v71 op_sel_hi:[1,0,0]
    v_fma_mix_f32 v28, v28, v60, v68 op_sel_hi:[1,0,0]
    v_fma_mix_f32 v29, v29, v61, v69 op_sel_hi:[1,0,0]
    v_fma_mix_f32 v30, v30, v62, v70 op_sel_hi:[1,0,0]
    v_fma_mix_f32 v31, v31, v63, v71 op_sel_hi:[1,0,0]
    v_cvt_pk_bf16_f32 v77, v24, v28
    v_cvt_pk_bf16_f32 v81, v25, v29
    v_cvt_pk_bf16_f32 v85, v26, v30
    v_cvt_pk_bf16_f32 v89, v27, v31
    v_fma_mix_f32 v32, v32, v60, v68 op_sel_hi:[1,0,0]
    v_fma_mix_f32 v33, v33, v61, v69 op_sel_hi:[1,0,0]
    v_fma_mix_f32 v34, v34, v62, v70 op_sel_hi:[1,0,0]
    v_fma_mix_f32 v35, v35, v63, v71 op_sel_hi:[1,0,0]
    v_fma_mix_f32 v36, v36, v60, v68 op_sel_hi:[1,0,0]
    v_fma_mix_f32 v37, v37, v61, v69 op_sel_hi:[1,0,0]
    v_fma_mix_f32 v38, v38, v62, v70 op_sel_hi:[1,0,0]
    v_fma_mix_f32 v39, v39, v63, v71 op_sel_hi:[1,0,0]
    v_cvt_pk_bf16_f32 v78, v32, v36
    v_cvt_pk_bf16_f32 v82, v33, v37
    v_cvt_pk_bf16_f32 v86, v34, v38
    v_cvt_pk_bf16_f32 v90, v35, v39
    v_fma_mix_f32 v40, v40, v60, v68 op_sel_hi:[1,0,0]
    v_fma_mix_f32 v41, v41, v61, v69 op_sel_hi:[1,0,0]
    v_fma_mix_f32 v42, v42, v62, v70 op_sel_hi:[1,0,0]
    v_fma_mix_f32 v43, v43, v63, v71 op_sel_hi:[1,0,0]
    v_fma_mix_f32 v44, v44, v60, v68 op_sel_hi:[1,0,0]
    v_fma_mix_f32 v45, v45, v61, v69 op_sel_hi:[1,0,0]
    v_fma_mix_f32 v46, v46, v62, v70 op_sel_hi:[1,0,0]
    v_fma_mix_f32 v47, v47, v63, v71 op_sel_hi:[1,0,0]
    v_cvt_pk_bf16_f32 v79, v40, v44
    v_cvt_pk_bf16_f32 v83, v41, v45
    v_cvt_pk_bf16_f32 v87, v42, v46
    v_cvt_pk_bf16_f32 v91, v43, v47
    v_fma_mix_f32 v48, v48, v64, v72 op_sel_hi:[1,0,0]
    v_fma_mix_f32 v49, v49, v65, v73 op_sel_hi:[1,0,0]
    v_fma_mix_f32 v50, v50, v66, v74 op_sel_hi:[1,0,0]
    v_fma_mix_f32 v51, v51, v67, v75 op_sel_hi:[1,0,0]
    v_cvt_pk_bf16_f32 v48, v48, v48
    v_cvt_pk_bf16_f32 v49, v49, v49
    v_cvt_pk_bf16_f32 v50, v50, v50
    v_cvt_pk_bf16_f32 v51, v51, v51
L_join7:
L_pw7:
    ds_read_b128 v[100:103], v13 offset:32
    ds_read_b128 v[104:107], v13 offset:48
    s_waitcnt lgkmcnt(0)
    v_min3_u32 v100, v100, v101, v102
    v_min3_u32 v100, v100, v103, v104
    v_min3_u32 v100, v100, v105, v106
    v_min_u32 v100, v100, v107
    s_nop 0
    v_readfirstlane_b32 s16, v100
    s_nop 0
    s_cmp_ge_u32 s16, 4
    s_cbranch_scc1 L_pok7
    s_sleep 1
    s_branch L_pw7
L_pok7:
    ds_write_b128 v5, v[76:79] offset:55296
    ds_write_b128 v5, v[80:83] offset:56320
    ds_write_b128 v5, v[84:87] offset:57344
    ds_write_b128 v5, v[88:91] offset:58368
    ds_write_b16 v7, v48 offset:55296
    ds_write_b16 v7, v49 offset:55312
    ds_write_b16 v7, v50 offset:55328
    ds_write_b16 v7, v51 offset:55344
    s_waitcnt lgkmcnt(0)
    v_mov_b32 v15, 8
    s_mov_b64 exec, 1
    ds_write_b32 v14, v15
    s_mov_b64 exec, -1
    s_endpgm
L_done:
    s_endpgm
L_slow0:
    s_waitcnt lgkmcnt(0)
    s_mov_b32 s59, 0
    buffer_load_dwordx2 v[52:53], v2, s[28:31], s59 offen
    buffer_load_dwordx2 v[54:55], v2, s[32:35], s59 offen
    buffer_load_dwordx2 v[56:57], v4, s[28:31], s59 offen
    buffer_load_dwordx2 v[58:59], v4, s[32:35], s59 offen
    s_waitcnt vmcnt(0)
    v_lshlrev_b32 v60, 16, v52
    v_and_b32 v61, 0xffff0000, v52
    v_lshlrev_b32 v62, 16, v53
    v_and_b32 v63, 0xffff0000, v53
    v_lshlrev_b32 v68, 16, v54
    v_and_b32 v69, 0xffff0000, v54
    v_lshlrev_b32 v70, 16, v55
    v_and_b32 v71, 0xffff0000, v55
    v_lshlrev_b32 v64, 16, v56
    v_and_b32 v65, 0xffff0000, v56
    v_lshlrev_b32 v66, 16, v57
    v_and_b32 v67, 0xffff0000, v57
    v_lshlrev_b32 v72, 16, v58
    v_and_b32 v73, 0xffff0000, v58
    v_lshlrev_b32 v74, 16, v59
    v_and_b32 v75, 0xffff0000, v59
    v_cvt_f32_i32 v16, v16
    v_cvt_f32_i32 v17, v17
    v_cvt_f32_i32 v18, v18
    v_cvt_f32_i32 v19, v19
    v_cvt_f32_i32 v20, v20
    v_cvt_f32_i32 v21, v21
    v_cvt_f32_i32 v22, v22
    v_cvt_f32_i32 v23, v23
    v_cvt_pk_bf16_f32 v16, 0, v16
    v_cvt_pk_bf16_f32 v17, 0, v17
    v_cvt_pk_bf16_f32 v18, 0, v18
    v_cvt_pk_bf16_f32 v19, 0, v19
    v_cvt_pk_bf16_f32 v20, 0, v20
    v_cvt_pk_bf16_f32 v21, 0, v21
    v_cvt_pk_bf16_f32 v22, 0, v22
    v_cvt_pk_bf16_f32 v23, 0, v23
    v_sub_f32 v16, v16, v68
    v_sub_f32 v17, v17, v69
    v_sub_f32 v18, v18, v70
    v_sub_f32 v19, v19, v71
    v_sub_f32 v20, v20, v68
    v_sub_f32 v21, v21, v69
    v_sub_f32 v22, v22, v70
    v_sub_f32 v23, v23, v71
    v_cvt_pk_bf16_f32 v16, 0, v16
    v_cvt_pk_bf16_f32 v17, 0, v17
    v_cvt_pk_bf16_f32 v18, 0, v18
    v_cvt_pk_bf16_f32 v19, 0, v19
    v_cvt_pk_bf16_f32 v20, 0, v20
    v_cvt_pk_bf16_f32 v21, 0, v21
    v_cvt_pk_bf16_f32 v22, 0, v22
    v_cvt_pk_bf16_f32 v23, 0, v23
    v_mul_f32 v16, v16, v60
    v_mul_f32 v17, v17, v61
    v_mul_f32 v18, v18, v62
    v_mul_f32 v19, v19, v63
    v_mul_f32 v20, v20, v60
    v_mul_f32 v21, v21, v61
    v_mul_f32 v22, v22, v62
    v_mul_f32 v23, v23, v63
    v_cvt_pk_bf16_f32 v76, v16, v20
    v_cvt_pk_bf16_f32 v80, v17, v21
    v_cvt_pk_bf16_f32 v84, v18, v22
    v_cvt_pk_bf16_f32 v88, v19, v23
    buffer_load_dwordx4 v[16:19], v1, s[24:27], s44 offen
    buffer_load_dwordx4 v[20:23], v1, s[24:27], s45 offen
    v_cvt_f32_i32 v24, v24
    v_cvt_f32_i32 v25, v25
    v_cvt_f32_i32 v26, v26
    v_cvt_f32_i32 v27, v27
    v_cvt_f32_i32 v28, v28
    v_cvt_f32_i32 v29, v29
    v_cvt_f32_i32 v30, v30
    v_cvt_f32_i32 v31, v31
    v_cvt_pk_bf16_f32 v24, 0, v24
    v_cvt_pk_bf16_f32 v25, 0, v25
    v_cvt_pk_bf16_f32 v26, 0, v26
    v_cvt_pk_bf16_f32 v27, 0, v27
    v_cvt_pk_bf16_f32 v28, 0, v28
    v_cvt_pk_bf16_f32 v29, 0, v29
    v_cvt_pk_bf16_f32 v30, 0, v30
    v_cvt_pk_bf16_f32 v31, 0, v31
    v_sub_f32 v24, v24, v68
    v_sub_f32 v25, v25, v69
    v_sub_f32 v26, v26, v70
    v_sub_f32 v27, v27, v71
    v_sub_f32 v28, v28, v68
    v_sub_f32 v29, v29, v69
    v_sub_f32 v30, v30, v70
    v_sub_f32 v31, v31, v71
    v_cvt_pk_bf16_f32 v24, 0, v24
    v_cvt_pk_bf16_f32 v25, 0, v25
    v_cvt_pk_bf16_f32 v26, 0, v26
    v_cvt_pk_bf16_f32 v27, 0, v27
    v_cvt_pk_bf16_f32 v28, 0, v28
    v_cvt_pk_bf16_f32 v29, 0, v29
    v_cvt_pk_bf16_f32 v30, 0, v30
    v_cvt_pk_bf16_f32 v31, 0, v31
    v_mul_f32 v24, v24, v60
    v_mul_f32 v25, v25, v61
    v_mul_f32 v26, v26, v62
    v_mul_f32 v27, v27, v63
    v_mul_f32 v28, v28, v60
    v_mul_f32 v29, v29, v61
    v_mul_f32 v30, v30, v62
    v_mul_f32 v31, v31, v63
    v_cvt_pk_bf16_f32 v77, v24, v28
    v_cvt_pk_bf16_f32 v81, v25, v29
    v_cvt_pk_bf16_f32 v85, v26, v30
    v_cvt_pk_bf16_f32 v89, v27, v31
    buffer_load_dwordx4 v[24:27], v1, s[24:27], s46 offen
    buffer_load_dwordx4 v[28:31], v1, s[24:27], s47 offen
    v_cvt_f32_i32 v32, v32
    v_cvt_f32_i32 v33, v33
    v_cvt_f32_i32 v34, v34
    v_cvt_f32_i32 v35, v35
    v_cvt_f32_i32 v36, v36
    v_cvt_f32_i32 v37, v37
    v_cvt_f32_i32 v38, v38
    v_cvt_f32_i32 v39, v39
    v_cvt_pk_bf16_f32 v32, 0, v32
    v_cvt_pk_bf16_f32 v33, 0, v33
    v_cvt_pk_bf16_f32 v34, 0, v34
    v_cvt_pk_bf16_f32 v35, 0, v35
    v_cvt_pk_bf16_f32 v36, 0, v36
    v_cvt_pk_bf16_f32 v37, 0, v37
    v_cvt_pk_bf16_f32 v38, 0, v38
    v_cvt_pk_bf16_f32 v39, 0, v39
    v_sub_f32 v32, v32, v68
    v_sub_f32 v33, v33, v69
    v_sub_f32 v34, v34, v70
    v_sub_f32 v35, v35, v71
    v_sub_f32 v36, v36, v68
    v_sub_f32 v37, v37, v69
    v_sub_f32 v38, v38, v70
    v_sub_f32 v39, v39, v71
    v_cvt_pk_bf16_f32 v32, 0, v32
    v_cvt_pk_bf16_f32 v33, 0, v33
    v_cvt_pk_bf16_f32 v34, 0, v34
    v_cvt_pk_bf16_f32 v35, 0, v35
    v_cvt_pk_bf16_f32 v36, 0, v36
    v_cvt_pk_bf16_f32 v37, 0, v37
    v_cvt_pk_bf16_f32 v38, 0, v38
    v_cvt_pk_bf16_f32 v39, 0, v39
    v_mul_f32 v32, v32, v60
    v_mul_f32 v33, v33, v61
    v_mul_f32 v34, v34, v62
    v_mul_f32 v35, v35, v63
    v_mul_f32 v36, v36, v60
    v_mul_f32 v37, v37, v61
    v_mul_f32 v38, v38, v62
    v_mul_f32 v39, v39, v63
    v_cvt_pk_bf16_f32 v78, v32, v36
    v_cvt_pk_bf16_f32 v82, v33, v37
    v_cvt_pk_bf16_f32 v86, v34, v38
    v_cvt_pk_bf16_f32 v90, v35, v39
    buffer_load_dwordx4 v[32:35], v1, s[24:27], s48 offen
    buffer_load_dwordx4 v[36:39], v1, s[24:27], s49 offen
    v_cvt_f32_i32 v40, v40
    v_cvt_f32_i32 v41, v41
    v_cvt_f32_i32 v42, v42
    v_cvt_f32_i32 v43, v43
    v_cvt_f32_i32 v44, v44
    v_cvt_f32_i32 v45, v45
    v_cvt_f32_i32 v46, v46
    v_cvt_f32_i32 v47, v47
    v_cvt_pk_bf16_f32 v40, 0, v40
    v_cvt_pk_bf16_f32 v41, 0, v41
    v_cvt_pk_bf16_f32 v42, 0, v42
    v_cvt_pk_bf16_f32 v43, 0, v43
    v_cvt_pk_bf16_f32 v44, 0, v44
    v_cvt_pk_bf16_f32 v45, 0, v45
    v_cvt_pk_bf16_f32 v46, 0, v46
    v_cvt_pk_bf16_f32 v47, 0, v47
    v_sub_f32 v40, v40, v68
    v_sub_f32 v41, v41, v69
    v_sub_f32 v42, v42, v70
    v_sub_f32 v43, v43, v71
    v_sub_f32 v44, v44, v68
    v_sub_f32 v45, v45, v69
    v_sub_f32 v46, v46, v70
    v_sub_f32 v47, v47, v71
    v_cvt_pk_bf16_f32 v40, 0, v40
    v_cvt_pk_bf16_f32 v41, 0, v41
    v_cvt_pk_bf16_f32 v42, 0, v42
    v_cvt_pk_bf16_f32 v43, 0, v43
    v_cvt_pk_bf16_f32 v44, 0, v44
    v_cvt_pk_bf16_f32 v45, 0, v45
    v_cvt_pk_bf16_f32 v46, 0, v46
    v_cvt_pk_bf16_f32 v47, 0, v47
    v_mul_f32 v40, v40, v60
    v_mul_f32 v41, v41, v61
    v_mul_f32 v42, v42, v62
    v_mul_f32 v43, v43, v63
    v_mul_f32 v44, v44, v60
    v_mul_f32 v45, v45, v61
    v_mul_f32 v46, v46, v62
    v_mul_f32 v47, v47, v63
    v_cvt_pk_bf16_f32 v79, v40, v44
    v_cvt_pk_bf16_f32 v83, v41, v45
    v_cvt_pk_bf16_f32 v87, v42, v46
    v_cvt_pk_bf16_f32 v91, v43, v47
    buffer_load_dwordx4 v[40:43], v1, s[24:27], s50 offen
    buffer_load_dwordx4 v[44:47], v1, s[24:27], s51 offen
    v_cvt_f32_i32 v48, v48
    v_cvt_f32_i32 v49, v49
    v_cvt_f32_i32 v50, v50
    v_cvt_f32_i32 v51, v51
    v_cvt_pk_bf16_f32 v48, 0, v48
    v_cvt_pk_bf16_f32 v49, 0, v49
    v_cvt_pk_bf16_f32 v50, 0, v50
    v_cvt_pk_bf16_f32 v51, 0, v51
    v_sub_f32 v48, v48, v72
    v_sub_f32 v49, v49, v73
    v_sub_f32 v50, v50, v74
    v_sub_f32 v51, v51, v75
    v_cvt_pk_bf16_f32 v48, 0, v48
    v_cvt_pk_bf16_f32 v49, 0, v49
    v_cvt_pk_bf16_f32 v50, 0, v50
    v_cvt_pk_bf16_f32 v51, 0, v51
    v_mul_f32 v48, v48, v64
    v_mul_f32 v49, v49, v65
    v_mul_f32 v50, v50, v66
    v_mul_f32 v51, v51, v67
    v_cvt_pk_bf16_f32 v48, v48, v48
    v_cvt_pk_bf16_f32 v49, v49, v49
    v_cvt_pk_bf16_f32 v50, v50, v50
    v_cvt_pk_bf16_f32 v51, v51, v51
    s_branch L_join0
L_slow2:
    s_waitcnt lgkmcnt(0)
    s_mov_b32 s59, 18432
    buffer_load_dwordx2 v[52:53], v2, s[28:31], s59 offen
    buffer_load_dwordx2 v[54:55], v2, s[32:35], s59 offen
    buffer_load_dwordx2 v[56:57], v4, s[28:31], s59 offen
    buffer_load_dwordx2 v[58:59], v4, s[32:35], s59 offen
    s_waitcnt vmcnt(0)
    v_lshlrev_b32 v60, 16, v52
    v_and_b32 v61, 0xffff0000, v52
    v_lshlrev_b32 v62, 16, v53
    v_and_b32 v63, 0xffff0000, v53
    v_lshlrev_b32 v68, 16, v54
    v_and_b32 v69, 0xffff0000, v54
    v_lshlrev_b32 v70, 16, v55
    v_and_b32 v71, 0xffff0000, v55
    v_lshlrev_b32 v64, 16, v56
    v_and_b32 v65, 0xffff0000, v56
    v_lshlrev_b32 v66, 16, v57
    v_and_b32 v67, 0xffff0000, v57
    v_lshlrev_b32 v72, 16, v58
    v_and_b32 v73, 0xffff0000, v58
    v_lshlrev_b32 v74, 16, v59
    v_and_b32 v75, 0xffff0000, v59
    v_cvt_f32_i32 v16, v16
    v_cvt_f32_i32 v17, v17
    v_cvt_f32_i32 v18, v18
    v_cvt_f32_i32 v19, v19
    v_cvt_f32_i32 v20, v20
    v_cvt_f32_i32 v21, v21
    v_cvt_f32_i32 v22, v22
    v_cvt_f32_i32 v23, v23
    v_cvt_pk_bf16_f32 v16, 0, v16
    v_cvt_pk_bf16_f32 v17, 0, v17
    v_cvt_pk_bf16_f32 v18, 0, v18
    v_cvt_pk_bf16_f32 v19, 0, v19
    v_cvt_pk_bf16_f32 v20, 0, v20
    v_cvt_pk_bf16_f32 v21, 0, v21
    v_cvt_pk_bf16_f32 v22, 0, v22
    v_cvt_pk_bf16_f32 v23, 0, v23
    v_sub_f32 v16, v16, v68
    v_sub_f32 v17, v17, v69
    v_sub_f32 v18, v18, v70
    v_sub_f32 v19, v19, v71
    v_sub_f32 v20, v20, v68
    v_sub_f32 v21, v21, v69
    v_sub_f32 v22, v22, v70
    v_sub_f32 v23, v23, v71
    v_cvt_pk_bf16_f32 v16, 0, v16
    v_cvt_pk_bf16_f32 v17, 0, v17
    v_cvt_pk_bf16_f32 v18, 0, v18
    v_cvt_pk_bf16_f32 v19, 0, v19
    v_cvt_pk_bf16_f32 v20, 0, v20
    v_cvt_pk_bf16_f32 v21, 0, v21
    v_cvt_pk_bf16_f32 v22, 0, v22
    v_cvt_pk_bf16_f32 v23, 0, v23
    v_mul_f32 v16, v16, v60
    v_mul_f32 v17, v17, v61
    v_mul_f32 v18, v18, v62
    v_mul_f32 v19, v19, v63
    v_mul_f32 v20, v20, v60
    v_mul_f32 v21, v21, v61
    v_mul_f32 v22, v22, v62
    v_mul_f32 v23, v23, v63
    v_cvt_pk_bf16_f32 v76, v16, v20
    v_cvt_pk_bf16_f32 v80, v17, v21
    v_cvt_pk_bf16_f32 v84, v18, v22
    v_cvt_pk_bf16_f32 v88, v19, v23
    buffer_load_dwordx4 v[16:19], v1, s[24:27], s44 offen
    buffer_load_dwordx4 v[20:23], v1, s[24:27], s45 offen
    v_cvt_f32_i32 v24, v24
    v_cvt_f32_i32 v25, v25
    v_cvt_f32_i32 v26, v26
    v_cvt_f32_i32 v27, v27
    v_cvt_f32_i32 v28, v28
    v_cvt_f32_i32 v29, v29
    v_cvt_f32_i32 v30, v30
    v_cvt_f32_i32 v31, v31
    v_cvt_pk_bf16_f32 v24, 0, v24
    v_cvt_pk_bf16_f32 v25, 0, v25
    v_cvt_pk_bf16_f32 v26, 0, v26
    v_cvt_pk_bf16_f32 v27, 0, v27
    v_cvt_pk_bf16_f32 v28, 0, v28
    v_cvt_pk_bf16_f32 v29, 0, v29
    v_cvt_pk_bf16_f32 v30, 0, v30
    v_cvt_pk_bf16_f32 v31, 0, v31
    v_sub_f32 v24, v24, v68
    v_sub_f32 v25, v25, v69
    v_sub_f32 v26, v26, v70
    v_sub_f32 v27, v27, v71
    v_sub_f32 v28, v28, v68
    v_sub_f32 v29, v29, v69
    v_sub_f32 v30, v30, v70
    v_sub_f32 v31, v31, v71
    v_cvt_pk_bf16_f32 v24, 0, v24
    v_cvt_pk_bf16_f32 v25, 0, v25
    v_cvt_pk_bf16_f32 v26, 0, v26
    v_cvt_pk_bf16_f32 v27, 0, v27
    v_cvt_pk_bf16_f32 v28, 0, v28
    v_cvt_pk_bf16_f32 v29, 0, v29
    v_cvt_pk_bf16_f32 v30, 0, v30
    v_cvt_pk_bf16_f32 v31, 0, v31
    v_mul_f32 v24, v24, v60
    v_mul_f32 v25, v25, v61
    v_mul_f32 v26, v26, v62
    v_mul_f32 v27, v27, v63
    v_mul_f32 v28, v28, v60
    v_mul_f32 v29, v29, v61
    v_mul_f32 v30, v30, v62
    v_mul_f32 v31, v31, v63
    v_cvt_pk_bf16_f32 v77, v24, v28
    v_cvt_pk_bf16_f32 v81, v25, v29
    v_cvt_pk_bf16_f32 v85, v26, v30
    v_cvt_pk_bf16_f32 v89, v27, v31
    buffer_load_dwordx4 v[24:27], v1, s[24:27], s46 offen
    buffer_load_dwordx4 v[28:31], v1, s[24:27], s47 offen
    v_cvt_f32_i32 v32, v32
    v_cvt_f32_i32 v33, v33
    v_cvt_f32_i32 v34, v34
    v_cvt_f32_i32 v35, v35
    v_cvt_f32_i32 v36, v36
    v_cvt_f32_i32 v37, v37
    v_cvt_f32_i32 v38, v38
    v_cvt_f32_i32 v39, v39
    v_cvt_pk_bf16_f32 v32, 0, v32
    v_cvt_pk_bf16_f32 v33, 0, v33
    v_cvt_pk_bf16_f32 v34, 0, v34
    v_cvt_pk_bf16_f32 v35, 0, v35
    v_cvt_pk_bf16_f32 v36, 0, v36
    v_cvt_pk_bf16_f32 v37, 0, v37
    v_cvt_pk_bf16_f32 v38, 0, v38
    v_cvt_pk_bf16_f32 v39, 0, v39
    v_sub_f32 v32, v32, v68
    v_sub_f32 v33, v33, v69
    v_sub_f32 v34, v34, v70
    v_sub_f32 v35, v35, v71
    v_sub_f32 v36, v36, v68
    v_sub_f32 v37, v37, v69
    v_sub_f32 v38, v38, v70
    v_sub_f32 v39, v39, v71
    v_cvt_pk_bf16_f32 v32, 0, v32
    v_cvt_pk_bf16_f32 v33, 0, v33
    v_cvt_pk_bf16_f32 v34, 0, v34
    v_cvt_pk_bf16_f32 v35, 0, v35
    v_cvt_pk_bf16_f32 v36, 0, v36
    v_cvt_pk_bf16_f32 v37, 0, v37
    v_cvt_pk_bf16_f32 v38, 0, v38
    v_cvt_pk_bf16_f32 v39, 0, v39
    v_mul_f32 v32, v32, v60
    v_mul_f32 v33, v33, v61
    v_mul_f32 v34, v34, v62
    v_mul_f32 v35, v35, v63
    v_mul_f32 v36, v36, v60
    v_mul_f32 v37, v37, v61
    v_mul_f32 v38, v38, v62
    v_mul_f32 v39, v39, v63
    v_cvt_pk_bf16_f32 v78, v32, v36
    v_cvt_pk_bf16_f32 v82, v33, v37
    v_cvt_pk_bf16_f32 v86, v34, v38
    v_cvt_pk_bf16_f32 v90, v35, v39
    buffer_load_dwordx4 v[32:35], v1, s[24:27], s48 offen
    buffer_load_dwordx4 v[36:39], v1, s[24:27], s49 offen
    v_cvt_f32_i32 v40, v40
    v_cvt_f32_i32 v41, v41
    v_cvt_f32_i32 v42, v42
    v_cvt_f32_i32 v43, v43
    v_cvt_f32_i32 v44, v44
    v_cvt_f32_i32 v45, v45
    v_cvt_f32_i32 v46, v46
    v_cvt_f32_i32 v47, v47
    v_cvt_pk_bf16_f32 v40, 0, v40
    v_cvt_pk_bf16_f32 v41, 0, v41
    v_cvt_pk_bf16_f32 v42, 0, v42
    v_cvt_pk_bf16_f32 v43, 0, v43
    v_cvt_pk_bf16_f32 v44, 0, v44
    v_cvt_pk_bf16_f32 v45, 0, v45
    v_cvt_pk_bf16_f32 v46, 0, v46
    v_cvt_pk_bf16_f32 v47, 0, v47
    v_sub_f32 v40, v40, v68
    v_sub_f32 v41, v41, v69
    v_sub_f32 v42, v42, v70
    v_sub_f32 v43, v43, v71
    v_sub_f32 v44, v44, v68
    v_sub_f32 v45, v45, v69
    v_sub_f32 v46, v46, v70
    v_sub_f32 v47, v47, v71
    v_cvt_pk_bf16_f32 v40, 0, v40
    v_cvt_pk_bf16_f32 v41, 0, v41
    v_cvt_pk_bf16_f32 v42, 0, v42
    v_cvt_pk_bf16_f32 v43, 0, v43
    v_cvt_pk_bf16_f32 v44, 0, v44
    v_cvt_pk_bf16_f32 v45, 0, v45
    v_cvt_pk_bf16_f32 v46, 0, v46
    v_cvt_pk_bf16_f32 v47, 0, v47
    v_mul_f32 v40, v40, v60
    v_mul_f32 v41, v41, v61
    v_mul_f32 v42, v42, v62
    v_mul_f32 v43, v43, v63
    v_mul_f32 v44, v44, v60
    v_mul_f32 v45, v45, v61
    v_mul_f32 v46, v46, v62
    v_mul_f32 v47, v47, v63
    v_cvt_pk_bf16_f32 v79, v40, v44
    v_cvt_pk_bf16_f32 v83, v41, v45
    v_cvt_pk_bf16_f32 v87, v42, v46
    v_cvt_pk_bf16_f32 v91, v43, v47
    buffer_load_dwordx4 v[40:43], v1, s[24:27], s50 offen
    buffer_load_dwordx4 v[44:47], v1, s[24:27], s51 offen
    v_cvt_f32_i32 v48, v48
    v_cvt_f32_i32 v49, v49
    v_cvt_f32_i32 v50, v50
    v_cvt_f32_i32 v51, v51
    v_cvt_pk_bf16_f32 v48, 0, v48
    v_cvt_pk_bf16_f32 v49, 0, v49
    v_cvt_pk_bf16_f32 v50, 0, v50
    v_cvt_pk_bf16_f32 v51, 0, v51
    v_sub_f32 v48, v48, v72
    v_sub_f32 v49, v49, v73
    v_sub_f32 v50, v50, v74
    v_sub_f32 v51, v51, v75
    v_cvt_pk_bf16_f32 v48, 0, v48
    v_cvt_pk_bf16_f32 v49, 0, v49
    v_cvt_pk_bf16_f32 v50, 0, v50
    v_cvt_pk_bf16_f32 v51, 0, v51
    v_mul_f32 v48, v48, v64
    v_mul_f32 v49, v49, v65
    v_mul_f32 v50, v50, v66
    v_mul_f32 v51, v51, v67
    v_cvt_pk_bf16_f32 v48, v48, v48
    v_cvt_pk_bf16_f32 v49, v49, v49
    v_cvt_pk_bf16_f32 v50, v50, v50
    v_cvt_pk_bf16_f32 v51, v51, v51
    s_branch L_join2
L_slow4:
    s_waitcnt lgkmcnt(0)
    s_mov_b32 s59, 36864
    buffer_load_dwordx2 v[52:53], v2, s[28:31], s59 offen
    buffer_load_dwordx2 v[54:55], v2, s[32:35], s59 offen
    buffer_load_dwordx2 v[56:57], v4, s[28:31], s59 offen
    buffer_load_dwordx2 v[58:59], v4, s[32:35], s59 offen
    s_waitcnt vmcnt(0)
    v_lshlrev_b32 v60, 16, v52
    v_and_b32 v61, 0xffff0000, v52
    v_lshlrev_b32 v62, 16, v53
    v_and_b32 v63, 0xffff0000, v53
    v_lshlrev_b32 v68, 16, v54
    v_and_b32 v69, 0xffff0000, v54
    v_lshlrev_b32 v70, 16, v55
    v_and_b32 v71, 0xffff0000, v55
    v_lshlrev_b32 v64, 16, v56
    v_and_b32 v65, 0xffff0000, v56
    v_lshlrev_b32 v66, 16, v57
    v_and_b32 v67, 0xffff0000, v57
    v_lshlrev_b32 v72, 16, v58
    v_and_b32 v73, 0xffff0000, v58
    v_lshlrev_b32 v74, 16, v59
    v_and_b32 v75, 0xffff0000, v59
    v_cvt_f32_i32 v16, v16
    v_cvt_f32_i32 v17, v17
    v_cvt_f32_i32 v18, v18
    v_cvt_f32_i32 v19, v19
    v_cvt_f32_i32 v20, v20
    v_cvt_f32_i32 v21, v21
    v_cvt_f32_i32 v22, v22
    v_cvt_f32_i32 v23, v23
    v_cvt_pk_bf16_f32 v16, 0, v16
    v_cvt_pk_bf16_f32 v17, 0, v17
    v_cvt_pk_bf16_f32 v18, 0, v18
    v_cvt_pk_bf16_f32 v19, 0, v19
    v_cvt_pk_bf16_f32 v20, 0, v20
    v_cvt_pk_bf16_f32 v21, 0, v21
    v_cvt_pk_bf16_f32 v22, 0, v22
    v_cvt_pk_bf16_f32 v23, 0, v23
    v_sub_f32 v16, v16, v68
    v_sub_f32 v17, v17, v69
    v_sub_f32 v18, v18, v70
    v_sub_f32 v19, v19, v71
    v_sub_f32 v20, v20, v68
    v_sub_f32 v21, v21, v69
    v_sub_f32 v22, v22, v70
    v_sub_f32 v23, v23, v71
    v_cvt_pk_bf16_f32 v16, 0, v16
    v_cvt_pk_bf16_f32 v17, 0, v17
    v_cvt_pk_bf16_f32 v18, 0, v18
    v_cvt_pk_bf16_f32 v19, 0, v19
    v_cvt_pk_bf16_f32 v20, 0, v20
    v_cvt_pk_bf16_f32 v21, 0, v21
    v_cvt_pk_bf16_f32 v22, 0, v22
    v_cvt_pk_bf16_f32 v23, 0, v23
    v_mul_f32 v16, v16, v60
    v_mul_f32 v17, v17, v61
    v_mul_f32 v18, v18, v62
    v_mul_f32 v19, v19, v63
    v_mul_f32 v20, v20, v60
    v_mul_f32 v21, v21, v61
    v_mul_f32 v22, v22, v62
    v_mul_f32 v23, v23, v63
    v_cvt_pk_bf16_f32 v76, v16, v20
    v_cvt_pk_bf16_f32 v80, v17, v21
    v_cvt_pk_bf16_f32 v84, v18, v22
    v_cvt_pk_bf16_f32 v88, v19, v23
    buffer_load_dwordx4 v[16:19], v1, s[24:27], s44 offen
    buffer_load_dwordx4 v[20:23], v1, s[24:27], s45 offen
    v_cvt_f32_i32 v24, v24
    v_cvt_f32_i32 v25, v25
    v_cvt_f32_i32 v26, v26
    v_cvt_f32_i32 v27, v27
    v_cvt_f32_i32 v28, v28
    v_cvt_f32_i32 v29, v29
    v_cvt_f32_i32 v30, v30
    v_cvt_f32_i32 v31, v31
    v_cvt_pk_bf16_f32 v24, 0, v24
    v_cvt_pk_bf16_f32 v25, 0, v25
    v_cvt_pk_bf16_f32 v26, 0, v26
    v_cvt_pk_bf16_f32 v27, 0, v27
    v_cvt_pk_bf16_f32 v28, 0, v28
    v_cvt_pk_bf16_f32 v29, 0, v29
    v_cvt_pk_bf16_f32 v30, 0, v30
    v_cvt_pk_bf16_f32 v31, 0, v31
    v_sub_f32 v24, v24, v68
    v_sub_f32 v25, v25, v69
    v_sub_f32 v26, v26, v70
    v_sub_f32 v27, v27, v71
    v_sub_f32 v28, v28, v68
    v_sub_f32 v29, v29, v69
    v_sub_f32 v30, v30, v70
    v_sub_f32 v31, v31, v71
    v_cvt_pk_bf16_f32 v24, 0, v24
    v_cvt_pk_bf16_f32 v25, 0, v25
    v_cvt_pk_bf16_f32 v26, 0, v26
    v_cvt_pk_bf16_f32 v27, 0, v27
    v_cvt_pk_bf16_f32 v28, 0, v28
    v_cvt_pk_bf16_f32 v29, 0, v29
    v_cvt_pk_bf16_f32 v30, 0, v30
    v_cvt_pk_bf16_f32 v31, 0, v31
    v_mul_f32 v24, v24, v60
    v_mul_f32 v25, v25, v61
    v_mul_f32 v26, v26, v62
    v_mul_f32 v27, v27, v63
    v_mul_f32 v28, v28, v60
    v_mul_f32 v29, v29, v61
    v_mul_f32 v30, v30, v62
    v_mul_f32 v31, v31, v63
    v_cvt_pk_bf16_f32 v77, v24, v28
    v_cvt_pk_bf16_f32 v81, v25, v29
    v_cvt_pk_bf16_f32 v85, v26, v30
    v_cvt_pk_bf16_f32 v89, v27, v31
    buffer_load_dwordx4 v[24:27], v1, s[24:27], s46 offen
    buffer_load_dwordx4 v[28:31], v1, s[24:27], s47 offen
    v_cvt_f32_i32 v32, v32
    v_cvt_f32_i32 v33, v33
    v_cvt_f32_i32 v34, v34
    v_cvt_f32_i32 v35, v35
    v_cvt_f32_i32 v36, v36
    v_cvt_f32_i32 v37, v37
    v_cvt_f32_i32 v38, v38
    v_cvt_f32_i32 v39, v39
    v_cvt_pk_bf16_f32 v32, 0, v32
    v_cvt_pk_bf16_f32 v33, 0, v33
    v_cvt_pk_bf16_f32 v34, 0, v34
    v_cvt_pk_bf16_f32 v35, 0, v35
    v_cvt_pk_bf16_f32 v36, 0, v36
    v_cvt_pk_bf16_f32 v37, 0, v37
    v_cvt_pk_bf16_f32 v38, 0, v38
    v_cvt_pk_bf16_f32 v39, 0, v39
    v_sub_f32 v32, v32, v68
    v_sub_f32 v33, v33, v69
    v_sub_f32 v34, v34, v70
    v_sub_f32 v35, v35, v71
    v_sub_f32 v36, v36, v68
    v_sub_f32 v37, v37, v69
    v_sub_f32 v38, v38, v70
    v_sub_f32 v39, v39, v71
    v_cvt_pk_bf16_f32 v32, 0, v32
    v_cvt_pk_bf16_f32 v33, 0, v33
    v_cvt_pk_bf16_f32 v34, 0, v34
    v_cvt_pk_bf16_f32 v35, 0, v35
    v_cvt_pk_bf16_f32 v36, 0, v36
    v_cvt_pk_bf16_f32 v37, 0, v37
    v_cvt_pk_bf16_f32 v38, 0, v38
    v_cvt_pk_bf16_f32 v39, 0, v39
    v_mul_f32 v32, v32, v60
    v_mul_f32 v33, v33, v61
    v_mul_f32 v34, v34, v62
    v_mul_f32 v35, v35, v63
    v_mul_f32 v36, v36, v60
    v_mul_f32 v37, v37, v61
    v_mul_f32 v38, v38, v62
    v_mul_f32 v39, v39, v63
    v_cvt_pk_bf16_f32 v78, v32, v36
    v_cvt_pk_bf16_f32 v82, v33, v37
    v_cvt_pk_bf16_f32 v86, v34, v38
    v_cvt_pk_bf16_f32 v90, v35, v39
    buffer_load_dwordx4 v[32:35], v1, s[24:27], s48 offen
    buffer_load_dwordx4 v[36:39], v1, s[24:27], s49 offen
    v_cvt_f32_i32 v40, v40
    v_cvt_f32_i32 v41, v41
    v_cvt_f32_i32 v42, v42
    v_cvt_f32_i32 v43, v43
    v_cvt_f32_i32 v44, v44
    v_cvt_f32_i32 v45, v45
    v_cvt_f32_i32 v46, v46
    v_cvt_f32_i32 v47, v47
    v_cvt_pk_bf16_f32 v40, 0, v40
    v_cvt_pk_bf16_f32 v41, 0, v41
    v_cvt_pk_bf16_f32 v42, 0, v42
    v_cvt_pk_bf16_f32 v43, 0, v43
    v_cvt_pk_bf16_f32 v44, 0, v44
    v_cvt_pk_bf16_f32 v45, 0, v45
    v_cvt_pk_bf16_f32 v46, 0, v46
    v_cvt_pk_bf16_f32 v47, 0, v47
    v_sub_f32 v40, v40, v68
    v_sub_f32 v41, v41, v69
    v_sub_f32 v42, v42, v70
    v_sub_f32 v43, v43, v71
    v_sub_f32 v44, v44, v68
    v_sub_f32 v45, v45, v69
    v_sub_f32 v46, v46, v70
    v_sub_f32 v47, v47, v71
    v_cvt_pk_bf16_f32 v40, 0, v40
    v_cvt_pk_bf16_f32 v41, 0, v41
    v_cvt_pk_bf16_f32 v42, 0, v42
    v_cvt_pk_bf16_f32 v43, 0, v43
    v_cvt_pk_bf16_f32 v44, 0, v44
    v_cvt_pk_bf16_f32 v45, 0, v45
    v_cvt_pk_bf16_f32 v46, 0, v46
    v_cvt_pk_bf16_f32 v47, 0, v47
    v_mul_f32 v40, v40, v60
    v_mul_f32 v41, v41, v61
    v_mul_f32 v42, v42, v62
    v_mul_f32 v43, v43, v63
    v_mul_f32 v44, v44, v60
    v_mul_f32 v45, v45, v61
    v_mul_f32 v46, v46, v62
    v_mul_f32 v47, v47, v63
    v_cvt_pk_bf16_f32 v79, v40, v44
    v_cvt_pk_bf16_f32 v83, v41, v45
    v_cvt_pk_bf16_f32 v87, v42, v46
    v_cvt_pk_bf16_f32 v91, v43, v47
    buffer_load_dwordx4 v[40:43], v1, s[24:27], s50 offen
    buffer_load_dwordx4 v[44:47], v1, s[24:27], s51 offen
    v_cvt_f32_i32 v48, v48
    v_cvt_f32_i32 v49, v49
    v_cvt_f32_i32 v50, v50
    v_cvt_f32_i32 v51, v51
    v_cvt_pk_bf16_f32 v48, 0, v48
    v_cvt_pk_bf16_f32 v49, 0, v49
    v_cvt_pk_bf16_f32 v50, 0, v50
    v_cvt_pk_bf16_f32 v51, 0, v51
    v_sub_f32 v48, v48, v72
    v_sub_f32 v49, v49, v73
    v_sub_f32 v50, v50, v74
    v_sub_f32 v51, v51, v75
    v_cvt_pk_bf16_f32 v48, 0, v48
    v_cvt_pk_bf16_f32 v49, 0, v49
    v_cvt_pk_bf16_f32 v50, 0, v50
    v_cvt_pk_bf16_f32 v51, 0, v51
    v_mul_f32 v48, v48, v64
    v_mul_f32 v49, v49, v65
    v_mul_f32 v50, v50, v66
    v_mul_f32 v51, v51, v67
    v_cvt_pk_bf16_f32 v48, v48, v48
    v_cvt_pk_bf16_f32 v49, v49, v49
    v_cvt_pk_bf16_f32 v50, v50, v50
    v_cvt_pk_bf16_f32 v51, v51, v51
    s_branch L_join4
L_slow6:
    s_waitcnt lgkmcnt(0)
    s_mov_b32 s59, 55296
    buffer_load_dwordx2 v[52:53], v2, s[28:31], s59 offen
    buffer_load_dwordx2 v[54:55], v2, s[32:35], s59 offen
    buffer_load_dwordx2 v[56:57], v4, s[28:31], s59 offen
    buffer_load_dwordx2 v[58:59], v4, s[32:35], s59 offen
    s_waitcnt vmcnt(0)
    v_lshlrev_b32 v60, 16, v52
    v_and_b32 v61, 0xffff0000, v52
    v_lshlrev_b32 v62, 16, v53
    v_and_b32 v63, 0xffff0000, v53
    v_lshlrev_b32 v68, 16, v54
    v_and_b32 v69, 0xffff0000, v54
    v_lshlrev_b32 v70, 16, v55
    v_and_b32 v71, 0xffff0000, v55
    v_lshlrev_b32 v64, 16, v56
    v_and_b32 v65, 0xffff0000, v56
    v_lshlrev_b32 v66, 16, v57
    v_and_b32 v67, 0xffff0000, v57
    v_lshlrev_b32 v72, 16, v58
    v_and_b32 v73, 0xffff0000, v58
    v_lshlrev_b32 v74, 16, v59
    v_and_b32 v75, 0xffff0000, v59
    v_cvt_f32_i32 v16, v16
    v_cvt_f32_i32 v17, v17
    v_cvt_f32_i32 v18, v18
    v_cvt_f32_i32 v19, v19
    v_cvt_f32_i32 v20, v20
    v_cvt_f32_i32 v21, v21
    v_cvt_f32_i32 v22, v22
    v_cvt_f32_i32 v23, v23
    v_cvt_pk_bf16_f32 v16, 0, v16
    v_cvt_pk_bf16_f32 v17, 0, v17
    v_cvt_pk_bf16_f32 v18, 0, v18
    v_cvt_pk_bf16_f32 v19, 0, v19
    v_cvt_pk_bf16_f32 v20, 0, v20
    v_cvt_pk_bf16_f32 v21, 0, v21
    v_cvt_pk_bf16_f32 v22, 0, v22
    v_cvt_pk_bf16_f32 v23, 0, v23
    v_sub_f32 v16, v16, v68
    v_sub_f32 v17, v17, v69
    v_sub_f32 v18, v18, v70
    v_sub_f32 v19, v19, v71
    v_sub_f32 v20, v20, v68
    v_sub_f32 v21, v21, v69
    v_sub_f32 v22, v22, v70
    v_sub_f32 v23, v23, v71
    v_cvt_pk_bf16_f32 v16, 0, v16
    v_cvt_pk_bf16_f32 v17, 0, v17
    v_cvt_pk_bf16_f32 v18, 0, v18
    v_cvt_pk_bf16_f32 v19, 0, v19
    v_cvt_pk_bf16_f32 v20, 0, v20
    v_cvt_pk_bf16_f32 v21, 0, v21
    v_cvt_pk_bf16_f32 v22, 0, v22
    v_cvt_pk_bf16_f32 v23, 0, v23
    v_mul_f32 v16, v16, v60
    v_mul_f32 v17, v17, v61
    v_mul_f32 v18, v18, v62
    v_mul_f32 v19, v19, v63
    v_mul_f32 v20, v20, v60
    v_mul_f32 v21, v21, v61
    v_mul_f32 v22, v22, v62
    v_mul_f32 v23, v23, v63
    v_cvt_pk_bf16_f32 v76, v16, v20
    v_cvt_pk_bf16_f32 v80, v17, v21
    v_cvt_pk_bf16_f32 v84, v18, v22
    v_cvt_pk_bf16_f32 v88, v19, v23
    buffer_load_dwordx4 v[16:19], v1, s[24:27], s44 offen
    buffer_load_dwordx4 v[20:23], v1, s[24:27], s45 offen
    v_cvt_f32_i32 v24, v24
    v_cvt_f32_i32 v25, v25
    v_cvt_f32_i32 v26, v26
    v_cvt_f32_i32 v27, v27
    v_cvt_f32_i32 v28, v28
    v_cvt_f32_i32 v29, v29
    v_cvt_f32_i32 v30, v30
    v_cvt_f32_i32 v31, v31
    v_cvt_pk_bf16_f32 v24, 0, v24
    v_cvt_pk_bf16_f32 v25, 0, v25
    v_cvt_pk_bf16_f32 v26, 0, v26
    v_cvt_pk_bf16_f32 v27, 0, v27
    v_cvt_pk_bf16_f32 v28, 0, v28
    v_cvt_pk_bf16_f32 v29, 0, v29
    v_cvt_pk_bf16_f32 v30, 0, v30
    v_cvt_pk_bf16_f32 v31, 0, v31
    v_sub_f32 v24, v24, v68
    v_sub_f32 v25, v25, v69
    v_sub_f32 v26, v26, v70
    v_sub_f32 v27, v27, v71
    v_sub_f32 v28, v28, v68
    v_sub_f32 v29, v29, v69
    v_sub_f32 v30, v30, v70
    v_sub_f32 v31, v31, v71
    v_cvt_pk_bf16_f32 v24, 0, v24
    v_cvt_pk_bf16_f32 v25, 0, v25
    v_cvt_pk_bf16_f32 v26, 0, v26
    v_cvt_pk_bf16_f32 v27, 0, v27
    v_cvt_pk_bf16_f32 v28, 0, v28
    v_cvt_pk_bf16_f32 v29, 0, v29
    v_cvt_pk_bf16_f32 v30, 0, v30
    v_cvt_pk_bf16_f32 v31, 0, v31
    v_mul_f32 v24, v24, v60
    v_mul_f32 v25, v25, v61
    v_mul_f32 v26, v26, v62
    v_mul_f32 v27, v27, v63
    v_mul_f32 v28, v28, v60
    v_mul_f32 v29, v29, v61
    v_mul_f32 v30, v30, v62
    v_mul_f32 v31, v31, v63
    v_cvt_pk_bf16_f32 v77, v24, v28
    v_cvt_pk_bf16_f32 v81, v25, v29
    v_cvt_pk_bf16_f32 v85, v26, v30
    v_cvt_pk_bf16_f32 v89, v27, v31
    buffer_load_dwordx4 v[24:27], v1, s[24:27], s46 offen
    buffer_load_dwordx4 v[28:31], v1, s[24:27], s47 offen
    v_cvt_f32_i32 v32, v32
    v_cvt_f32_i32 v33, v33
    v_cvt_f32_i32 v34, v34
    v_cvt_f32_i32 v35, v35
    v_cvt_f32_i32 v36, v36
    v_cvt_f32_i32 v37, v37
    v_cvt_f32_i32 v38, v38
    v_cvt_f32_i32 v39, v39
    v_cvt_pk_bf16_f32 v32, 0, v32
    v_cvt_pk_bf16_f32 v33, 0, v33
    v_cvt_pk_bf16_f32 v34, 0, v34
    v_cvt_pk_bf16_f32 v35, 0, v35
    v_cvt_pk_bf16_f32 v36, 0, v36
    v_cvt_pk_bf16_f32 v37, 0, v37
    v_cvt_pk_bf16_f32 v38, 0, v38
    v_cvt_pk_bf16_f32 v39, 0, v39
    v_sub_f32 v32, v32, v68
    v_sub_f32 v33, v33, v69
    v_sub_f32 v34, v34, v70
    v_sub_f32 v35, v35, v71
    v_sub_f32 v36, v36, v68
    v_sub_f32 v37, v37, v69
    v_sub_f32 v38, v38, v70
    v_sub_f32 v39, v39, v71
    v_cvt_pk_bf16_f32 v32, 0, v32
    v_cvt_pk_bf16_f32 v33, 0, v33
    v_cvt_pk_bf16_f32 v34, 0, v34
    v_cvt_pk_bf16_f32 v35, 0, v35
    v_cvt_pk_bf16_f32 v36, 0, v36
    v_cvt_pk_bf16_f32 v37, 0, v37
    v_cvt_pk_bf16_f32 v38, 0, v38
    v_cvt_pk_bf16_f32 v39, 0, v39
    v_mul_f32 v32, v32, v60
    v_mul_f32 v33, v33, v61
    v_mul_f32 v34, v34, v62
    v_mul_f32 v35, v35, v63
    v_mul_f32 v36, v36, v60
    v_mul_f32 v37, v37, v61
    v_mul_f32 v38, v38, v62
    v_mul_f32 v39, v39, v63
    v_cvt_pk_bf16_f32 v78, v32, v36
    v_cvt_pk_bf16_f32 v82, v33, v37
    v_cvt_pk_bf16_f32 v86, v34, v38
    v_cvt_pk_bf16_f32 v90, v35, v39
    buffer_load_dwordx4 v[32:35], v1, s[24:27], s48 offen
    buffer_load_dwordx4 v[36:39], v1, s[24:27], s49 offen
    v_cvt_f32_i32 v40, v40
    v_cvt_f32_i32 v41, v41
    v_cvt_f32_i32 v42, v42
    v_cvt_f32_i32 v43, v43
    v_cvt_f32_i32 v44, v44
    v_cvt_f32_i32 v45, v45
    v_cvt_f32_i32 v46, v46
    v_cvt_f32_i32 v47, v47
    v_cvt_pk_bf16_f32 v40, 0, v40
    v_cvt_pk_bf16_f32 v41, 0, v41
    v_cvt_pk_bf16_f32 v42, 0, v42
    v_cvt_pk_bf16_f32 v43, 0, v43
    v_cvt_pk_bf16_f32 v44, 0, v44
    v_cvt_pk_bf16_f32 v45, 0, v45
    v_cvt_pk_bf16_f32 v46, 0, v46
    v_cvt_pk_bf16_f32 v47, 0, v47
    v_sub_f32 v40, v40, v68
    v_sub_f32 v41, v41, v69
    v_sub_f32 v42, v42, v70
    v_sub_f32 v43, v43, v71
    v_sub_f32 v44, v44, v68
    v_sub_f32 v45, v45, v69
    v_sub_f32 v46, v46, v70
    v_sub_f32 v47, v47, v71
    v_cvt_pk_bf16_f32 v40, 0, v40
    v_cvt_pk_bf16_f32 v41, 0, v41
    v_cvt_pk_bf16_f32 v42, 0, v42
    v_cvt_pk_bf16_f32 v43, 0, v43
    v_cvt_pk_bf16_f32 v44, 0, v44
    v_cvt_pk_bf16_f32 v45, 0, v45
    v_cvt_pk_bf16_f32 v46, 0, v46
    v_cvt_pk_bf16_f32 v47, 0, v47
    v_mul_f32 v40, v40, v60
    v_mul_f32 v41, v41, v61
    v_mul_f32 v42, v42, v62
    v_mul_f32 v43, v43, v63
    v_mul_f32 v44, v44, v60
    v_mul_f32 v45, v45, v61
    v_mul_f32 v46, v46, v62
    v_mul_f32 v47, v47, v63
    v_cvt_pk_bf16_f32 v79, v40, v44
    v_cvt_pk_bf16_f32 v83, v41, v45
    v_cvt_pk_bf16_f32 v87, v42, v46
    v_cvt_pk_bf16_f32 v91, v43, v47
    buffer_load_dwordx4 v[40:43], v1, s[24:27], s50 offen
    buffer_load_dwordx4 v[44:47], v1, s[24:27], s51 offen
    v_cvt_f32_i32 v48, v48
    v_cvt_f32_i32 v49, v49
    v_cvt_f32_i32 v50, v50
    v_cvt_f32_i32 v51, v51
    v_cvt_pk_bf16_f32 v48, 0, v48
    v_cvt_pk_bf16_f32 v49, 0, v49
    v_cvt_pk_bf16_f32 v50, 0, v50
    v_cvt_pk_bf16_f32 v51, 0, v51
    v_sub_f32 v48, v48, v72
    v_sub_f32 v49, v49, v73
    v_sub_f32 v50, v50, v74
    v_sub_f32 v51, v51, v75
    v_cvt_pk_bf16_f32 v48, 0, v48
    v_cvt_pk_bf16_f32 v49, 0, v49
    v_cvt_pk_bf16_f32 v50, 0, v50
    v_cvt_pk_bf16_f32 v51, 0, v51
    v_mul_f32 v48, v48, v64
    v_mul_f32 v49, v49, v65
    v_mul_f32 v50, v50, v66
    v_mul_f32 v51, v51, v67
    v_cvt_pk_bf16_f32 v48, v48, v48
    v_cvt_pk_bf16_f32 v49, v49, v49
    v_cvt_pk_bf16_f32 v50, v50, v50
    v_cvt_pk_bf16_f32 v51, v51, v51
    s_branch L_join6
L_slow8:
    s_waitcnt lgkmcnt(0)
    s_mov_b32 s59, 73728
    buffer_load_dwordx2 v[52:53], v2, s[28:31], s59 offen
    buffer_load_dwordx2 v[54:55], v2, s[32:35], s59 offen
    buffer_load_dwordx2 v[56:57], v4, s[28:31], s59 offen
    buffer_load_dwordx2 v[58:59], v4, s[32:35], s59 offen
    s_waitcnt vmcnt(0)
    v_lshlrev_b32 v60, 16, v52
    v_and_b32 v61, 0xffff0000, v52
    v_lshlrev_b32 v62, 16, v53
    v_and_b32 v63, 0xffff0000, v53
    v_lshlrev_b32 v68, 16, v54
    v_and_b32 v69, 0xffff0000, v54
    v_lshlrev_b32 v70, 16, v55
    v_and_b32 v71, 0xffff0000, v55
    v_lshlrev_b32 v64, 16, v56
    v_and_b32 v65, 0xffff0000, v56
    v_lshlrev_b32 v66, 16, v57
    v_and_b32 v67, 0xffff0000, v57
    v_lshlrev_b32 v72, 16, v58
    v_and_b32 v73, 0xffff0000, v58
    v_lshlrev_b32 v74, 16, v59
    v_and_b32 v75, 0xffff0000, v59
    v_cvt_f32_i32 v16, v16
    v_cvt_f32_i32 v17, v17
    v_cvt_f32_i32 v18, v18
    v_cvt_f32_i32 v19, v19
    v_cvt_f32_i32 v20, v20
    v_cvt_f32_i32 v21, v21
    v_cvt_f32_i32 v22, v22
    v_cvt_f32_i32 v23, v23
    v_cvt_pk_bf16_f32 v16, 0, v16
    v_cvt_pk_bf16_f32 v17, 0, v17
    v_cvt_pk_bf16_f32 v18, 0, v18
    v_cvt_pk_bf16_f32 v19, 0, v19
    v_cvt_pk_bf16_f32 v20, 0, v20
    v_cvt_pk_bf16_f32 v21, 0, v21
    v_cvt_pk_bf16_f32 v22, 0, v22
    v_cvt_pk_bf16_f32 v23, 0, v23
    v_sub_f32 v16, v16, v68
    v_sub_f32 v17, v17, v69
    v_sub_f32 v18, v18, v70
    v_sub_f32 v19, v19, v71
    v_sub_f32 v20, v20, v68
    v_sub_f32 v21, v21, v69
    v_sub_f32 v22, v22, v70
    v_sub_f32 v23, v23, v71
    v_cvt_pk_bf16_f32 v16, 0, v16
    v_cvt_pk_bf16_f32 v17, 0, v17
    v_cvt_pk_bf16_f32 v18, 0, v18
    v_cvt_pk_bf16_f32 v19, 0, v19
    v_cvt_pk_bf16_f32 v20, 0, v20
    v_cvt_pk_bf16_f32 v21, 0, v21
    v_cvt_pk_bf16_f32 v22, 0, v22
    v_cvt_pk_bf16_f32 v23, 0, v23
    v_mul_f32 v16, v16, v60
    v_mul_f32 v17, v17, v61
    v_mul_f32 v18, v18, v62
    v_mul_f32 v19, v19, v63
    v_mul_f32 v20, v20, v60
    v_mul_f32 v21, v21, v61
    v_mul_f32 v22, v22, v62
    v_mul_f32 v23, v23, v63
    v_cvt_pk_bf16_f32 v76, v16, v20
    v_cvt_pk_bf16_f32 v80, v17, v21
    v_cvt_pk_bf16_f32 v84, v18, v22
    v_cvt_pk_bf16_f32 v88, v19, v23
    v_cvt_f32_i32 v24, v24
    v_cvt_f32_i32 v25, v25
    v_cvt_f32_i32 v26, v26
    v_cvt_f32_i32 v27, v27
    v_cvt_f32_i32 v28, v28
    v_cvt_f32_i32 v29, v29
    v_cvt_f32_i32 v30, v30
    v_cvt_f32_i32 v31, v31
    v_cvt_pk_bf16_f32 v24, 0, v24
    v_cvt_pk_bf16_f32 v25, 0, v25
    v_cvt_pk_bf16_f32 v26, 0, v26
    v_cvt_pk_bf16_f32 v27, 0, v27
    v_cvt_pk_bf16_f32 v28, 0, v28
    v_cvt_pk_bf16_f32 v29, 0, v29
    v_cvt_pk_bf16_f32 v30, 0, v30
    v_cvt_pk_bf16_f32 v31, 0, v31
    v_sub_f32 v24, v24, v68
    v_sub_f32 v25, v25, v69
    v_sub_f32 v26, v26, v70
    v_sub_f32 v27, v27, v71
    v_sub_f32 v28, v28, v68
    v_sub_f32 v29, v29, v69
    v_sub_f32 v30, v30, v70
    v_sub_f32 v31, v31, v71
    v_cvt_pk_bf16_f32 v24, 0, v24
    v_cvt_pk_bf16_f32 v25, 0, v25
    v_cvt_pk_bf16_f32 v26, 0, v26
    v_cvt_pk_bf16_f32 v27, 0, v27
    v_cvt_pk_bf16_f32 v28, 0, v28
    v_cvt_pk_bf16_f32 v29, 0, v29
    v_cvt_pk_bf16_f32 v30, 0, v30
    v_cvt_pk_bf16_f32 v31, 0, v31
    v_mul_f32 v24, v24, v60
    v_mul_f32 v25, v25, v61
    v_mul_f32 v26, v26, v62
    v_mul_f32 v27, v27, v63
    v_mul_f32 v28, v28, v60
    v_mul_f32 v29, v29, v61
    v_mul_f32 v30, v30, v62
    v_mul_f32 v31, v31, v63
    v_cvt_pk_bf16_f32 v77, v24, v28
    v_cvt_pk_bf16_f32 v81, v25, v29
    v_cvt_pk_bf16_f32 v85, v26, v30
    v_cvt_pk_bf16_f32 v89, v27, v31
    v_cvt_f32_i32 v32, v32
    v_cvt_f32_i32 v33, v33
    v_cvt_f32_i32 v34, v34
    v_cvt_f32_i32 v35, v35
    v_cvt_f32_i32 v36, v36
    v_cvt_f32_i32 v37, v37
    v_cvt_f32_i32 v38, v38
    v_cvt_f32_i32 v39, v39
    v_cvt_pk_bf16_f32 v32, 0, v32
    v_cvt_pk_bf16_f32 v33, 0, v33
    v_cvt_pk_bf16_f32 v34, 0, v34
    v_cvt_pk_bf16_f32 v35, 0, v35
    v_cvt_pk_bf16_f32 v36, 0, v36
    v_cvt_pk_bf16_f32 v37, 0, v37
    v_cvt_pk_bf16_f32 v38, 0, v38
    v_cvt_pk_bf16_f32 v39, 0, v39
    v_sub_f32 v32, v32, v68
    v_sub_f32 v33, v33, v69
    v_sub_f32 v34, v34, v70
    v_sub_f32 v35, v35, v71
    v_sub_f32 v36, v36, v68
    v_sub_f32 v37, v37, v69
    v_sub_f32 v38, v38, v70
    v_sub_f32 v39, v39, v71
    v_cvt_pk_bf16_f32 v32, 0, v32
    v_cvt_pk_bf16_f32 v33, 0, v33
    v_cvt_pk_bf16_f32 v34, 0, v34
    v_cvt_pk_bf16_f32 v35, 0, v35
    v_cvt_pk_bf16_f32 v36, 0, v36
    v_cvt_pk_bf16_f32 v37, 0, v37
    v_cvt_pk_bf16_f32 v38, 0, v38
    v_cvt_pk_bf16_f32 v39, 0, v39
    v_mul_f32 v32, v32, v60
    v_mul_f32 v33, v33, v61
    v_mul_f32 v34, v34, v62
    v_mul_f32 v35, v35, v63
    v_mul_f32 v36, v36, v60
    v_mul_f32 v37, v37, v61
    v_mul_f32 v38, v38, v62
    v_mul_f32 v39, v39, v63
    v_cvt_pk_bf16_f32 v78, v32, v36
    v_cvt_pk_bf16_f32 v82, v33, v37
    v_cvt_pk_bf16_f32 v86, v34, v38
    v_cvt_pk_bf16_f32 v90, v35, v39
    v_cvt_f32_i32 v40, v40
    v_cvt_f32_i32 v41, v41
    v_cvt_f32_i32 v42, v42
    v_cvt_f32_i32 v43, v43
    v_cvt_f32_i32 v44, v44
    v_cvt_f32_i32 v45, v45
    v_cvt_f32_i32 v46, v46
    v_cvt_f32_i32 v47, v47
    v_cvt_pk_bf16_f32 v40, 0, v40
    v_cvt_pk_bf16_f32 v41, 0, v41
    v_cvt_pk_bf16_f32 v42, 0, v42
    v_cvt_pk_bf16_f32 v43, 0, v43
    v_cvt_pk_bf16_f32 v44, 0, v44
    v_cvt_pk_bf16_f32 v45, 0, v45
    v_cvt_pk_bf16_f32 v46, 0, v46
    v_cvt_pk_bf16_f32 v47, 0, v47
    v_sub_f32 v40, v40, v68
    v_sub_f32 v41, v41, v69
    v_sub_f32 v42, v42, v70
    v_sub_f32 v43, v43, v71
    v_sub_f32 v44, v44, v68
    v_sub_f32 v45, v45, v69
    v_sub_f32 v46, v46, v70
    v_sub_f32 v47, v47, v71
    v_cvt_pk_bf16_f32 v40, 0, v40
    v_cvt_pk_bf16_f32 v41, 0, v41
    v_cvt_pk_bf16_f32 v42, 0, v42
    v_cvt_pk_bf16_f32 v43, 0, v43
    v_cvt_pk_bf16_f32 v44, 0, v44
    v_cvt_pk_bf16_f32 v45, 0, v45
    v_cvt_pk_bf16_f32 v46, 0, v46
    v_cvt_pk_bf16_f32 v47, 0, v47
    v_mul_f32 v40, v40, v60
    v_mul_f32 v41, v41, v61
    v_mul_f32 v42, v42, v62
    v_mul_f32 v43, v43, v63
    v_mul_f32 v44, v44, v60
    v_mul_f32 v45, v45, v61
    v_mul_f32 v46, v46, v62
    v_mul_f32 v47, v47, v63
    v_cvt_pk_bf16_f32 v79, v40, v44
    v_cvt_pk_bf16_f32 v83, v41, v45
    v_cvt_pk_bf16_f32 v87, v42, v46
    v_cvt_pk_bf16_f32 v91, v43, v47
    v_cvt_f32_i32 v48, v48
    v_cvt_f32_i32 v49, v49
    v_cvt_f32_i32 v50, v50
    v_cvt_f32_i32 v51, v51
    v_cvt_pk_bf16_f32 v48, 0, v48
    v_cvt_pk_bf16_f32 v49, 0, v49
    v_cvt_pk_bf16_f32 v50, 0, v50
    v_cvt_pk_bf16_f32 v51, 0, v51
    v_sub_f32 v48, v48, v72
    v_sub_f32 v49, v49, v73
    v_sub_f32 v50, v50, v74
    v_sub_f32 v51, v51, v75
    v_cvt_pk_bf16_f32 v48, 0, v48
    v_cvt_pk_bf16_f32 v49, 0, v49
    v_cvt_pk_bf16_f32 v50, 0, v50
    v_cvt_pk_bf16_f32 v51, 0, v51
    v_mul_f32 v48, v48, v64
    v_mul_f32 v49, v49, v65
    v_mul_f32 v50, v50, v66
    v_mul_f32 v51, v51, v67
    v_cvt_pk_bf16_f32 v48, v48, v48
    v_cvt_pk_bf16_f32 v49, v49, v49
    v_cvt_pk_bf16_f32 v50, v50, v50
    v_cvt_pk_bf16_f32 v51, v51, v51
    s_branch L_join8
L_slow1:
    s_waitcnt lgkmcnt(0)
    s_mov_b32 s59, 9216
    buffer_load_dwordx2 v[52:53], v2, s[28:31], s59 offen
    buffer_load_dwordx2 v[54:55], v2, s[32:35], s59 offen
    buffer_load_dwordx2 v[56:57], v4, s[28:31], s59 offen
    buffer_load_dwordx2 v[58:59], v4, s[32:35], s59 offen
    s_waitcnt vmcnt(0)
    v_lshlrev_b32 v60, 16, v52
    v_and_b32 v61, 0xffff0000, v52
    v_lshlrev_b32 v62, 16, v53
    v_and_b32 v63, 0xffff0000, v53
    v_lshlrev_b32 v68, 16, v54
    v_and_b32 v69, 0xffff0000, v54
    v_lshlrev_b32 v70, 16, v55
    v_and_b32 v71, 0xffff0000, v55
    v_lshlrev_b32 v64, 16, v56
    v_and_b32 v65, 0xffff0000, v56
    v_lshlrev_b32 v66, 16, v57
    v_and_b32 v67, 0xffff0000, v57
    v_lshlrev_b32 v72, 16, v58
    v_and_b32 v73, 0xffff0000, v58
    v_lshlrev_b32 v74, 16, v59
    v_and_b32 v75, 0xffff0000, v59
    v_cvt_f32_i32 v16, v16
    v_cvt_f32_i32 v17, v17
    v_cvt_f32_i32 v18, v18
    v_cvt_f32_i32 v19, v19
    v_cvt_f32_i32 v20, v20
    v_cvt_f32_i32 v21, v21
    v_cvt_f32_i32 v22, v22
    v_cvt_f32_i32 v23, v23
    v_cvt_pk_bf16_f32 v16, 0, v16
    v_cvt_pk_bf16_f32 v17, 0, v17
    v_cvt_pk_bf16_f32 v18, 0, v18
    v_cvt_pk_bf16_f32 v19, 0, v19
    v_cvt_pk_bf16_f32 v20, 0, v20
    v_cvt_pk_bf16_f32 v21, 0, v21
    v_cvt_pk_bf16_f32 v22, 0, v22
    v_cvt_pk_bf16_f32 v23, 0, v23
    v_sub_f32 v16, v16, v68
    v_sub_f32 v17, v17, v69
    v_sub_f32 v18, v18, v70
    v_sub_f32 v19, v19, v71
    v_sub_f32 v20, v20, v68
    v_sub_f32 v21, v21, v69
    v_sub_f32 v22, v22, v70
    v_sub_f32 v23, v23, v71
    v_cvt_pk_bf16_f32 v16, 0, v16
    v_cvt_pk_bf16_f32 v17, 0, v17
    v_cvt_pk_bf16_f32 v18, 0, v18
    v_cvt_pk_bf16_f32 v19, 0, v19
    v_cvt_pk_bf16_f32 v20, 0, v20
    v_cvt_pk_bf16_f32 v21, 0, v21
    v_cvt_pk_bf16_f32 v22, 0, v22
    v_cvt_pk_bf16_f32 v23, 0, v23
    v_mul_f32 v16, v16, v60
    v_mul_f32 v17, v17, v61
    v_mul_f32 v18, v18, v62
    v_mul_f32 v19, v19, v63
    v_mul_f32 v20, v20, v60
    v_mul_f32 v21, v21, v61
    v_mul_f32 v22, v22, v62
    v_mul_f32 v23, v23, v63
    v_cvt_pk_bf16_f32 v76, v16, v20
    v_cvt_pk_bf16_f32 v80, v17, v21
    v_cvt_pk_bf16_f32 v84, v18, v22
    v_cvt_pk_bf16_f32 v88, v19, v23
    buffer_load_dwordx4 v[16:19], v1, s[24:27], s44 offen
    buffer_load_dwordx4 v[20:23], v1, s[24:27], s45 offen
    v_cvt_f32_i32 v24, v24
    v_cvt_f32_i32 v25, v25
    v_cvt_f32_i32 v26, v26
    v_cvt_f32_i32 v27, v27
    v_cvt_f32_i32 v28, v28
    v_cvt_f32_i32 v29, v29
    v_cvt_f32_i32 v30, v30
    v_cvt_f32_i32 v31, v31
    v_cvt_pk_bf16_f32 v24, 0, v24
    v_cvt_pk_bf16_f32 v25, 0, v25
    v_cvt_pk_bf16_f32 v26, 0, v26
    v_cvt_pk_bf16_f32 v27, 0, v27
    v_cvt_pk_bf16_f32 v28, 0, v28
    v_cvt_pk_bf16_f32 v29, 0, v29
    v_cvt_pk_bf16_f32 v30, 0, v30
    v_cvt_pk_bf16_f32 v31, 0, v31
    v_sub_f32 v24, v24, v68
    v_sub_f32 v25, v25, v69
    v_sub_f32 v26, v26, v70
    v_sub_f32 v27, v27, v71
    v_sub_f32 v28, v28, v68
    v_sub_f32 v29, v29, v69
    v_sub_f32 v30, v30, v70
    v_sub_f32 v31, v31, v71
    v_cvt_pk_bf16_f32 v24, 0, v24
    v_cvt_pk_bf16_f32 v25, 0, v25
    v_cvt_pk_bf16_f32 v26, 0, v26
    v_cvt_pk_bf16_f32 v27, 0, v27
    v_cvt_pk_bf16_f32 v28, 0, v28
    v_cvt_pk_bf16_f32 v29, 0, v29
    v_cvt_pk_bf16_f32 v30, 0, v30
    v_cvt_pk_bf16_f32 v31, 0, v31
    v_mul_f32 v24, v24, v60
    v_mul_f32 v25, v25, v61
    v_mul_f32 v26, v26, v62
    v_mul_f32 v27, v27, v63
    v_mul_f32 v28, v28, v60
    v_mul_f32 v29, v29, v61
    v_mul_f32 v30, v30, v62
    v_mul_f32 v31, v31, v63
    v_cvt_pk_bf16_f32 v77, v24, v28
    v_cvt_pk_bf16_f32 v81, v25, v29
    v_cvt_pk_bf16_f32 v85, v26, v30
    v_cvt_pk_bf16_f32 v89, v27, v31
    buffer_load_dwordx4 v[24:27], v1, s[24:27], s46 offen
    buffer_load_dwordx4 v[28:31], v1, s[24:27], s47 offen
    v_cvt_f32_i32 v32, v32
    v_cvt_f32_i32 v33, v33
    v_cvt_f32_i32 v34, v34
    v_cvt_f32_i32 v35, v35
    v_cvt_f32_i32 v36, v36
    v_cvt_f32_i32 v37, v37
    v_cvt_f32_i32 v38, v38
    v_cvt_f32_i32 v39, v39
    v_cvt_pk_bf16_f32 v32, 0, v32
    v_cvt_pk_bf16_f32 v33, 0, v33
    v_cvt_pk_bf16_f32 v34, 0, v34
    v_cvt_pk_bf16_f32 v35, 0, v35
    v_cvt_pk_bf16_f32 v36, 0, v36
    v_cvt_pk_bf16_f32 v37, 0, v37
    v_cvt_pk_bf16_f32 v38, 0, v38
    v_cvt_pk_bf16_f32 v39, 0, v39
    v_sub_f32 v32, v32, v68
    v_sub_f32 v33, v33, v69
    v_sub_f32 v34, v34, v70
    v_sub_f32 v35, v35, v71
    v_sub_f32 v36, v36, v68
    v_sub_f32 v37, v37, v69
    v_sub_f32 v38, v38, v70
    v_sub_f32 v39, v39, v71
    v_cvt_pk_bf16_f32 v32, 0, v32
    v_cvt_pk_bf16_f32 v33, 0, v33
    v_cvt_pk_bf16_f32 v34, 0, v34
    v_cvt_pk_bf16_f32 v35, 0, v35
    v_cvt_pk_bf16_f32 v36, 0, v36
    v_cvt_pk_bf16_f32 v37, 0, v37
    v_cvt_pk_bf16_f32 v38, 0, v38
    v_cvt_pk_bf16_f32 v39, 0, v39
    v_mul_f32 v32, v32, v60
    v_mul_f32 v33, v33, v61
    v_mul_f32 v34, v34, v62
    v_mul_f32 v35, v35, v63
    v_mul_f32 v36, v36, v60
    v_mul_f32 v37, v37, v61
    v_mul_f32 v38, v38, v62
    v_mul_f32 v39, v39, v63
    v_cvt_pk_bf16_f32 v78, v32, v36
    v_cvt_pk_bf16_f32 v82, v33, v37
    v_cvt_pk_bf16_f32 v86, v34, v38
    v_cvt_pk_bf16_f32 v90, v35, v39
    buffer_load_dwordx4 v[32:35], v1, s[24:27], s48 offen
    buffer_load_dwordx4 v[36:39], v1, s[24:27], s49 offen
    v_cvt_f32_i32 v40, v40
    v_cvt_f32_i32 v41, v41
    v_cvt_f32_i32 v42, v42
    v_cvt_f32_i32 v43, v43
    v_cvt_f32_i32 v44, v44
    v_cvt_f32_i32 v45, v45
    v_cvt_f32_i32 v46, v46
    v_cvt_f32_i32 v47, v47
    v_cvt_pk_bf16_f32 v40, 0, v40
    v_cvt_pk_bf16_f32 v41, 0, v41
    v_cvt_pk_bf16_f32 v42, 0, v42
    v_cvt_pk_bf16_f32 v43, 0, v43
    v_cvt_pk_bf16_f32 v44, 0, v44
    v_cvt_pk_bf16_f32 v45, 0, v45
    v_cvt_pk_bf16_f32 v46, 0, v46
    v_cvt_pk_bf16_f32 v47, 0, v47
    v_sub_f32 v40, v40, v68
    v_sub_f32 v41, v41, v69
    v_sub_f32 v42, v42, v70
    v_sub_f32 v43, v43, v71
    v_sub_f32 v44, v44, v68
    v_sub_f32 v45, v45, v69
    v_sub_f32 v46, v46, v70
    v_sub_f32 v47, v47, v71
    v_cvt_pk_bf16_f32 v40, 0, v40
    v_cvt_pk_bf16_f32 v41, 0, v41
    v_cvt_pk_bf16_f32 v42, 0, v42
    v_cvt_pk_bf16_f32 v43, 0, v43
    v_cvt_pk_bf16_f32 v44, 0, v44
    v_cvt_pk_bf16_f32 v45, 0, v45
    v_cvt_pk_bf16_f32 v46, 0, v46
    v_cvt_pk_bf16_f32 v47, 0, v47
    v_mul_f32 v40, v40, v60
    v_mul_f32 v41, v41, v61
    v_mul_f32 v42, v42, v62
    v_mul_f32 v43, v43, v63
    v_mul_f32 v44, v44, v60
    v_mul_f32 v45, v45, v61
    v_mul_f32 v46, v46, v62
    v_mul_f32 v47, v47, v63
    v_cvt_pk_bf16_f32 v79, v40, v44
    v_cvt_pk_bf16_f32 v83, v41, v45
    v_cvt_pk_bf16_f32 v87, v42, v46
    v_cvt_pk_bf16_f32 v91, v43, v47
    buffer_load_dwordx4 v[40:43], v1, s[24:27], s50 offen
    buffer_load_dwordx4 v[44:47], v1, s[24:27], s51 offen
    v_cvt_f32_i32 v48, v48
    v_cvt_f32_i32 v49, v49
    v_cvt_f32_i32 v50, v50
    v_cvt_f32_i32 v51, v51
    v_cvt_pk_bf16_f32 v48, 0, v48
    v_cvt_pk_bf16_f32 v49, 0, v49
    v_cvt_pk_bf16_f32 v50, 0, v50
    v_cvt_pk_bf16_f32 v51, 0, v51
    v_sub_f32 v48, v48, v72
    v_sub_f32 v49, v49, v73
    v_sub_f32 v50, v50, v74
    v_sub_f32 v51, v51, v75
    v_cvt_pk_bf16_f32 v48, 0, v48
    v_cvt_pk_bf16_f32 v49, 0, v49
    v_cvt_pk_bf16_f32 v50, 0, v50
    v_cvt_pk_bf16_f32 v51, 0, v51
    v_mul_f32 v48, v48, v64
    v_mul_f32 v49, v49, v65
    v_mul_f32 v50, v50, v66
    v_mul_f32 v51, v51, v67
    v_cvt_pk_bf16_f32 v48, v48, v48
    v_cvt_pk_bf16_f32 v49, v49, v49
    v_cvt_pk_bf16_f32 v50, v50, v50
    v_cvt_pk_bf16_f32 v51, v51, v51
    s_branch L_join1
L_slow3:
    s_waitcnt lgkmcnt(0)
    s_mov_b32 s59, 27648
    buffer_load_dwordx2 v[52:53], v2, s[28:31], s59 offen
    buffer_load_dwordx2 v[54:55], v2, s[32:35], s59 offen
    buffer_load_dwordx2 v[56:57], v4, s[28:31], s59 offen
    buffer_load_dwordx2 v[58:59], v4, s[32:35], s59 offen
    s_waitcnt vmcnt(0)
    v_lshlrev_b32 v60, 16, v52
    v_and_b32 v61, 0xffff0000, v52
    v_lshlrev_b32 v62, 16, v53
    v_and_b32 v63, 0xffff0000, v53
    v_lshlrev_b32 v68, 16, v54
    v_and_b32 v69, 0xffff0000, v54
    v_lshlrev_b32 v70, 16, v55
    v_and_b32 v71, 0xffff0000, v55
    v_lshlrev_b32 v64, 16, v56
    v_and_b32 v65, 0xffff0000, v56
    v_lshlrev_b32 v66, 16, v57
    v_and_b32 v67, 0xffff0000, v57
    v_lshlrev_b32 v72, 16, v58
    v_and_b32 v73, 0xffff0000, v58
    v_lshlrev_b32 v74, 16, v59
    v_and_b32 v75, 0xffff0000, v59
    v_cvt_f32_i32 v16, v16
    v_cvt_f32_i32 v17, v17
    v_cvt_f32_i32 v18, v18
    v_cvt_f32_i32 v19, v19
    v_cvt_f32_i32 v20, v20
    v_cvt_f32_i32 v21, v21
    v_cvt_f32_i32 v22, v22
    v_cvt_f32_i32 v23, v23
    v_cvt_pk_bf16_f32 v16, 0, v16
    v_cvt_pk_bf16_f32 v17, 0, v17
    v_cvt_pk_bf16_f32 v18, 0, v18
    v_cvt_pk_bf16_f32 v19, 0, v19
    v_cvt_pk_bf16_f32 v20, 0, v20
    v_cvt_pk_bf16_f32 v21, 0, v21
    v_cvt_pk_bf16_f32 v22, 0, v22
    v_cvt_pk_bf16_f32 v23, 0, v23
    v_sub_f32 v16, v16, v68
    v_sub_f32 v17, v17, v69
    v_sub_f32 v18, v18, v70
    v_sub_f32 v19, v19, v71
    v_sub_f32 v20, v20, v68
    v_sub_f32 v21, v21, v69
    v_sub_f32 v22, v22, v70
    v_sub_f32 v23, v23, v71
    v_cvt_pk_bf16_f32 v16, 0, v16
    v_cvt_pk_bf16_f32 v17, 0, v17
    v_cvt_pk_bf16_f32 v18, 0, v18
    v_cvt_pk_bf16_f32 v19, 0, v19
    v_cvt_pk_bf16_f32 v20, 0, v20
    v_cvt_pk_bf16_f32 v21, 0, v21
    v_cvt_pk_bf16_f32 v22, 0, v22
    v_cvt_pk_bf16_f32 v23, 0, v23
    v_mul_f32 v16, v16, v60
    v_mul_f32 v17, v17, v61
    v_mul_f32 v18, v18, v62
    v_mul_f32 v19, v19, v63
    v_mul_f32 v20, v20, v60
    v_mul_f32 v21, v21, v61
    v_mul_f32 v22, v22, v62
    v_mul_f32 v23, v23, v63
    v_cvt_pk_bf16_f32 v76, v16, v20
    v_cvt_pk_bf16_f32 v80, v17, v21
    v_cvt_pk_bf16_f32 v84, v18, v22
    v_cvt_pk_bf16_f32 v88, v19, v23
    buffer_load_dwordx4 v[16:19], v1, s[24:27], s44 offen
    buffer_load_dwordx4 v[20:23], v1, s[24:27], s45 offen
    v_cvt_f32_i32 v24, v24
    v_cvt_f32_i32 v25, v25
    v_cvt_f32_i32 v26, v26
    v_cvt_f32_i32 v27, v27
    v_cvt_f32_i32 v28, v28
    v_cvt_f32_i32 v29, v29
    v_cvt_f32_i32 v30, v30
    v_cvt_f32_i32 v31, v31
    v_cvt_pk_bf16_f32 v24, 0, v24
    v_cvt_pk_bf16_f32 v25, 0, v25
    v_cvt_pk_bf16_f32 v26, 0, v26
    v_cvt_pk_bf16_f32 v27, 0, v27
    v_cvt_pk_bf16_f32 v28, 0, v28
    v_cvt_pk_bf16_f32 v29, 0, v29
    v_cvt_pk_bf16_f32 v30, 0, v30
    v_cvt_pk_bf16_f32 v31, 0, v31
    v_sub_f32 v24, v24, v68
    v_sub_f32 v25, v25, v69
    v_sub_f32 v26, v26, v70
    v_sub_f32 v27, v27, v71
    v_sub_f32 v28, v28, v68
    v_sub_f32 v29, v29, v69
    v_sub_f32 v30, v30, v70
    v_sub_f32 v31, v31, v71
    v_cvt_pk_bf16_f32 v24, 0, v24
    v_cvt_pk_bf16_f32 v25, 0, v25
    v_cvt_pk_bf16_f32 v26, 0, v26
    v_cvt_pk_bf16_f32 v27, 0, v27
    v_cvt_pk_bf16_f32 v28, 0, v28
    v_cvt_pk_bf16_f32 v29, 0, v29
    v_cvt_pk_bf16_f32 v30, 0, v30
    v_cvt_pk_bf16_f32 v31, 0, v31
    v_mul_f32 v24, v24, v60
    v_mul_f32 v25, v25, v61
    v_mul_f32 v26, v26, v62
    v_mul_f32 v27, v27, v63
    v_mul_f32 v28, v28, v60
    v_mul_f32 v29, v29, v61
    v_mul_f32 v30, v30, v62
    v_mul_f32 v31, v31, v63
    v_cvt_pk_bf16_f32 v77, v24, v28
    v_cvt_pk_bf16_f32 v81, v25, v29
    v_cvt_pk_bf16_f32 v85, v26, v30
    v_cvt_pk_bf16_f32 v89, v27, v31
    buffer_load_dwordx4 v[24:27], v1, s[24:27], s46 offen
    buffer_load_dwordx4 v[28:31], v1, s[24:27], s47 offen
    v_cvt_f32_i32 v32, v32
    v_cvt_f32_i32 v33, v33
    v_cvt_f32_i32 v34, v34
    v_cvt_f32_i32 v35, v35
    v_cvt_f32_i32 v36, v36
    v_cvt_f32_i32 v37, v37
    v_cvt_f32_i32 v38, v38
    v_cvt_f32_i32 v39, v39
    v_cvt_pk_bf16_f32 v32, 0, v32
    v_cvt_pk_bf16_f32 v33, 0, v33
    v_cvt_pk_bf16_f32 v34, 0, v34
    v_cvt_pk_bf16_f32 v35, 0, v35
    v_cvt_pk_bf16_f32 v36, 0, v36
    v_cvt_pk_bf16_f32 v37, 0, v37
    v_cvt_pk_bf16_f32 v38, 0, v38
    v_cvt_pk_bf16_f32 v39, 0, v39
    v_sub_f32 v32, v32, v68
    v_sub_f32 v33, v33, v69
    v_sub_f32 v34, v34, v70
    v_sub_f32 v35, v35, v71
    v_sub_f32 v36, v36, v68
    v_sub_f32 v37, v37, v69
    v_sub_f32 v38, v38, v70
    v_sub_f32 v39, v39, v71
    v_cvt_pk_bf16_f32 v32, 0, v32
    v_cvt_pk_bf16_f32 v33, 0, v33
    v_cvt_pk_bf16_f32 v34, 0, v34
    v_cvt_pk_bf16_f32 v35, 0, v35
    v_cvt_pk_bf16_f32 v36, 0, v36
    v_cvt_pk_bf16_f32 v37, 0, v37
    v_cvt_pk_bf16_f32 v38, 0, v38
    v_cvt_pk_bf16_f32 v39, 0, v39
    v_mul_f32 v32, v32, v60
    v_mul_f32 v33, v33, v61
    v_mul_f32 v34, v34, v62
    v_mul_f32 v35, v35, v63
    v_mul_f32 v36, v36, v60
    v_mul_f32 v37, v37, v61
    v_mul_f32 v38, v38, v62
    v_mul_f32 v39, v39, v63
    v_cvt_pk_bf16_f32 v78, v32, v36
    v_cvt_pk_bf16_f32 v82, v33, v37
    v_cvt_pk_bf16_f32 v86, v34, v38
    v_cvt_pk_bf16_f32 v90, v35, v39
    buffer_load_dwordx4 v[32:35], v1, s[24:27], s48 offen
    buffer_load_dwordx4 v[36:39], v1, s[24:27], s49 offen
    v_cvt_f32_i32 v40, v40
    v_cvt_f32_i32 v41, v41
    v_cvt_f32_i32 v42, v42
    v_cvt_f32_i32 v43, v43
    v_cvt_f32_i32 v44, v44
    v_cvt_f32_i32 v45, v45
    v_cvt_f32_i32 v46, v46
    v_cvt_f32_i32 v47, v47
    v_cvt_pk_bf16_f32 v40, 0, v40
    v_cvt_pk_bf16_f32 v41, 0, v41
    v_cvt_pk_bf16_f32 v42, 0, v42
    v_cvt_pk_bf16_f32 v43, 0, v43
    v_cvt_pk_bf16_f32 v44, 0, v44
    v_cvt_pk_bf16_f32 v45, 0, v45
    v_cvt_pk_bf16_f32 v46, 0, v46
    v_cvt_pk_bf16_f32 v47, 0, v47
    v_sub_f32 v40, v40, v68
    v_sub_f32 v41, v41, v69
    v_sub_f32 v42, v42, v70
    v_sub_f32 v43, v43, v71
    v_sub_f32 v44, v44, v68
    v_sub_f32 v45, v45, v69
    v_sub_f32 v46, v46, v70
    v_sub_f32 v47, v47, v71
    v_cvt_pk_bf16_f32 v40, 0, v40
    v_cvt_pk_bf16_f32 v41, 0, v41
    v_cvt_pk_bf16_f32 v42, 0, v42
    v_cvt_pk_bf16_f32 v43, 0, v43
    v_cvt_pk_bf16_f32 v44, 0, v44
    v_cvt_pk_bf16_f32 v45, 0, v45
    v_cvt_pk_bf16_f32 v46, 0, v46
    v_cvt_pk_bf16_f32 v47, 0, v47
    v_mul_f32 v40, v40, v60
    v_mul_f32 v41, v41, v61
    v_mul_f32 v42, v42, v62
    v_mul_f32 v43, v43, v63
    v_mul_f32 v44, v44, v60
    v_mul_f32 v45, v45, v61
    v_mul_f32 v46, v46, v62
    v_mul_f32 v47, v47, v63
    v_cvt_pk_bf16_f32 v79, v40, v44
    v_cvt_pk_bf16_f32 v83, v41, v45
    v_cvt_pk_bf16_f32 v87, v42, v46
    v_cvt_pk_bf16_f32 v91, v43, v47
    buffer_load_dwordx4 v[40:43], v1, s[24:27], s50 offen
    buffer_load_dwordx4 v[44:47], v1, s[24:27], s51 offen
    v_cvt_f32_i32 v48, v48
    v_cvt_f32_i32 v49, v49
    v_cvt_f32_i32 v50, v50
    v_cvt_f32_i32 v51, v51
    v_cvt_pk_bf16_f32 v48, 0, v48
    v_cvt_pk_bf16_f32 v49, 0, v49
    v_cvt_pk_bf16_f32 v50, 0, v50
    v_cvt_pk_bf16_f32 v51, 0, v51
    v_sub_f32 v48, v48, v72
    v_sub_f32 v49, v49, v73
    v_sub_f32 v50, v50, v74
    v_sub_f32 v51, v51, v75
    v_cvt_pk_bf16_f32 v48, 0, v48
    v_cvt_pk_bf16_f32 v49, 0, v49
    v_cvt_pk_bf16_f32 v50, 0, v50
    v_cvt_pk_bf16_f32 v51, 0, v51
    v_mul_f32 v48, v48, v64
    v_mul_f32 v49, v49, v65
    v_mul_f32 v50, v50, v66
    v_mul_f32 v51, v51, v67
    v_cvt_pk_bf16_f32 v48, v48, v48
    v_cvt_pk_bf16_f32 v49, v49, v49
    v_cvt_pk_bf16_f32 v50, v50, v50
    v_cvt_pk_bf16_f32 v51, v51, v51
    s_branch L_join3
L_slow5:
    s_waitcnt lgkmcnt(0)
    s_mov_b32 s59, 46080
    buffer_load_dwordx2 v[52:53], v2, s[28:31], s59 offen
    buffer_load_dwordx2 v[54:55], v2, s[32:35], s59 offen
    buffer_load_dwordx2 v[56:57], v4, s[28:31], s59 offen
    buffer_load_dwordx2 v[58:59], v4, s[32:35], s59 offen
    s_waitcnt vmcnt(0)
    v_lshlrev_b32 v60, 16, v52
    v_and_b32 v61, 0xffff0000, v52
    v_lshlrev_b32 v62, 16, v53
    v_and_b32 v63, 0xffff0000, v53
    v_lshlrev_b32 v68, 16, v54
    v_and_b32 v69, 0xffff0000, v54
    v_lshlrev_b32 v70, 16, v55
    v_and_b32 v71, 0xffff0000, v55
    v_lshlrev_b32 v64, 16, v56
    v_and_b32 v65, 0xffff0000, v56
    v_lshlrev_b32 v66, 16, v57
    v_and_b32 v67, 0xffff0000, v57
    v_lshlrev_b32 v72, 16, v58
    v_and_b32 v73, 0xffff0000, v58
    v_lshlrev_b32 v74, 16, v59
    v_and_b32 v75, 0xffff0000, v59
    v_cvt_f32_i32 v16, v16
    v_cvt_f32_i32 v17, v17
    v_cvt_f32_i32 v18, v18
    v_cvt_f32_i32 v19, v19
    v_cvt_f32_i32 v20, v20
    v_cvt_f32_i32 v21, v21
    v_cvt_f32_i32 v22, v22
    v_cvt_f32_i32 v23, v23
    v_cvt_pk_bf16_f32 v16, 0, v16
    v_cvt_pk_bf16_f32 v17, 0, v17
    v_cvt_pk_bf16_f32 v18, 0, v18
    v_cvt_pk_bf16_f32 v19, 0, v19
    v_cvt_pk_bf16_f32 v20, 0, v20
    v_cvt_pk_bf16_f32 v21, 0, v21
    v_cvt_pk_bf16_f32 v22, 0, v22
    v_cvt_pk_bf16_f32 v23, 0, v23
    v_sub_f32 v16, v16, v68
    v_sub_f32 v17, v17, v69
    v_sub_f32 v18, v18, v70
    v_sub_f32 v19, v19, v71
    v_sub_f32 v20, v20, v68
    v_sub_f32 v21, v21, v69
    v_sub_f32 v22, v22, v70
    v_sub_f32 v23, v23, v71
    v_cvt_pk_bf16_f32 v16, 0, v16
    v_cvt_pk_bf16_f32 v17, 0, v17
    v_cvt_pk_bf16_f32 v18, 0, v18
    v_cvt_pk_bf16_f32 v19, 0, v19
    v_cvt_pk_bf16_f32 v20, 0, v20
    v_cvt_pk_bf16_f32 v21, 0, v21
    v_cvt_pk_bf16_f32 v22, 0, v22
    v_cvt_pk_bf16_f32 v23, 0, v23
    v_mul_f32 v16, v16, v60
    v_mul_f32 v17, v17, v61
    v_mul_f32 v18, v18, v62
    v_mul_f32 v19, v19, v63
    v_mul_f32 v20, v20, v60
    v_mul_f32 v21, v21, v61
    v_mul_f32 v22, v22, v62
    v_mul_f32 v23, v23, v63
    v_cvt_pk_bf16_f32 v76, v16, v20
    v_cvt_pk_bf16_f32 v80, v17, v21
    v_cvt_pk_bf16_f32 v84, v18, v22
    v_cvt_pk_bf16_f32 v88, v19, v23
    buffer_load_dwordx4 v[16:19], v1, s[24:27], s44 offen
    buffer_load_dwordx4 v[20:23], v1, s[24:27], s45 offen
    v_cvt_f32_i32 v24, v24
    v_cvt_f32_i32 v25, v25
    v_cvt_f32_i32 v26, v26
    v_cvt_f32_i32 v27, v27
    v_cvt_f32_i32 v28, v28
    v_cvt_f32_i32 v29, v29
    v_cvt_f32_i32 v30, v30
    v_cvt_f32_i32 v31, v31
    v_cvt_pk_bf16_f32 v24, 0, v24
    v_cvt_pk_bf16_f32 v25, 0, v25
    v_cvt_pk_bf16_f32 v26, 0, v26
    v_cvt_pk_bf16_f32 v27, 0, v27
    v_cvt_pk_bf16_f32 v28, 0, v28
    v_cvt_pk_bf16_f32 v29, 0, v29
    v_cvt_pk_bf16_f32 v30, 0, v30
    v_cvt_pk_bf16_f32 v31, 0, v31
    v_sub_f32 v24, v24, v68
    v_sub_f32 v25, v25, v69
    v_sub_f32 v26, v26, v70
    v_sub_f32 v27, v27, v71
    v_sub_f32 v28, v28, v68
    v_sub_f32 v29, v29, v69
    v_sub_f32 v30, v30, v70
    v_sub_f32 v31, v31, v71
    v_cvt_pk_bf16_f32 v24, 0, v24
    v_cvt_pk_bf16_f32 v25, 0, v25
    v_cvt_pk_bf16_f32 v26, 0, v26
    v_cvt_pk_bf16_f32 v27, 0, v27
    v_cvt_pk_bf16_f32 v28, 0, v28
    v_cvt_pk_bf16_f32 v29, 0, v29
    v_cvt_pk_bf16_f32 v30, 0, v30
    v_cvt_pk_bf16_f32 v31, 0, v31
    v_mul_f32 v24, v24, v60
    v_mul_f32 v25, v25, v61
    v_mul_f32 v26, v26, v62
    v_mul_f32 v27, v27, v63
    v_mul_f32 v28, v28, v60
    v_mul_f32 v29, v29, v61
    v_mul_f32 v30, v30, v62
    v_mul_f32 v31, v31, v63
    v_cvt_pk_bf16_f32 v77, v24, v28
    v_cvt_pk_bf16_f32 v81, v25, v29
    v_cvt_pk_bf16_f32 v85, v26, v30
    v_cvt_pk_bf16_f32 v89, v27, v31
    buffer_load_dwordx4 v[24:27], v1, s[24:27], s46 offen
    buffer_load_dwordx4 v[28:31], v1, s[24:27], s47 offen
    v_cvt_f32_i32 v32, v32
    v_cvt_f32_i32 v33, v33
    v_cvt_f32_i32 v34, v34
    v_cvt_f32_i32 v35, v35
    v_cvt_f32_i32 v36, v36
    v_cvt_f32_i32 v37, v37
    v_cvt_f32_i32 v38, v38
    v_cvt_f32_i32 v39, v39
    v_cvt_pk_bf16_f32 v32, 0, v32
    v_cvt_pk_bf16_f32 v33, 0, v33
    v_cvt_pk_bf16_f32 v34, 0, v34
    v_cvt_pk_bf16_f32 v35, 0, v35
    v_cvt_pk_bf16_f32 v36, 0, v36
    v_cvt_pk_bf16_f32 v37, 0, v37
    v_cvt_pk_bf16_f32 v38, 0, v38
    v_cvt_pk_bf16_f32 v39, 0, v39
    v_sub_f32 v32, v32, v68
    v_sub_f32 v33, v33, v69
    v_sub_f32 v34, v34, v70
    v_sub_f32 v35, v35, v71
    v_sub_f32 v36, v36, v68
    v_sub_f32 v37, v37, v69
    v_sub_f32 v38, v38, v70
    v_sub_f32 v39, v39, v71
    v_cvt_pk_bf16_f32 v32, 0, v32
    v_cvt_pk_bf16_f32 v33, 0, v33
    v_cvt_pk_bf16_f32 v34, 0, v34
    v_cvt_pk_bf16_f32 v35, 0, v35
    v_cvt_pk_bf16_f32 v36, 0, v36
    v_cvt_pk_bf16_f32 v37, 0, v37
    v_cvt_pk_bf16_f32 v38, 0, v38
    v_cvt_pk_bf16_f32 v39, 0, v39
    v_mul_f32 v32, v32, v60
    v_mul_f32 v33, v33, v61
    v_mul_f32 v34, v34, v62
    v_mul_f32 v35, v35, v63
    v_mul_f32 v36, v36, v60
    v_mul_f32 v37, v37, v61
    v_mul_f32 v38, v38, v62
    v_mul_f32 v39, v39, v63
    v_cvt_pk_bf16_f32 v78, v32, v36
    v_cvt_pk_bf16_f32 v82, v33, v37
    v_cvt_pk_bf16_f32 v86, v34, v38
    v_cvt_pk_bf16_f32 v90, v35, v39
    buffer_load_dwordx4 v[32:35], v1, s[24:27], s48 offen
    buffer_load_dwordx4 v[36:39], v1, s[24:27], s49 offen
    v_cvt_f32_i32 v40, v40
    v_cvt_f32_i32 v41, v41
    v_cvt_f32_i32 v42, v42
    v_cvt_f32_i32 v43, v43
    v_cvt_f32_i32 v44, v44
    v_cvt_f32_i32 v45, v45
    v_cvt_f32_i32 v46, v46
    v_cvt_f32_i32 v47, v47
    v_cvt_pk_bf16_f32 v40, 0, v40
    v_cvt_pk_bf16_f32 v41, 0, v41
    v_cvt_pk_bf16_f32 v42, 0, v42
    v_cvt_pk_bf16_f32 v43, 0, v43
    v_cvt_pk_bf16_f32 v44, 0, v44
    v_cvt_pk_bf16_f32 v45, 0, v45
    v_cvt_pk_bf16_f32 v46, 0, v46
    v_cvt_pk_bf16_f32 v47, 0, v47
    v_sub_f32 v40, v40, v68
    v_sub_f32 v41, v41, v69
    v_sub_f32 v42, v42, v70
    v_sub_f32 v43, v43, v71
    v_sub_f32 v44, v44, v68
    v_sub_f32 v45, v45, v69
    v_sub_f32 v46, v46, v70
    v_sub_f32 v47, v47, v71
    v_cvt_pk_bf16_f32 v40, 0, v40
    v_cvt_pk_bf16_f32 v41, 0, v41
    v_cvt_pk_bf16_f32 v42, 0, v42
    v_cvt_pk_bf16_f32 v43, 0, v43
    v_cvt_pk_bf16_f32 v44, 0, v44
    v_cvt_pk_bf16_f32 v45, 0, v45
    v_cvt_pk_bf16_f32 v46, 0, v46
    v_cvt_pk_bf16_f32 v47, 0, v47
    v_mul_f32 v40, v40, v60
    v_mul_f32 v41, v41, v61
    v_mul_f32 v42, v42, v62
    v_mul_f32 v43, v43, v63
    v_mul_f32 v44, v44, v60
    v_mul_f32 v45, v45, v61
    v_mul_f32 v46, v46, v62
    v_mul_f32 v47, v47, v63
    v_cvt_pk_bf16_f32 v79, v40, v44
    v_cvt_pk_bf16_f32 v83, v41, v45
    v_cvt_pk_bf16_f32 v87, v42, v46
    v_cvt_pk_bf16_f32 v91, v43, v47
    buffer_load_dwordx4 v[40:43], v1, s[24:27], s50 offen
    buffer_load_dwordx4 v[44:47], v1, s[24:27], s51 offen
    v_cvt_f32_i32 v48, v48
    v_cvt_f32_i32 v49, v49
    v_cvt_f32_i32 v50, v50
    v_cvt_f32_i32 v51, v51
    v_cvt_pk_bf16_f32 v48, 0, v48
    v_cvt_pk_bf16_f32 v49, 0, v49
    v_cvt_pk_bf16_f32 v50, 0, v50
    v_cvt_pk_bf16_f32 v51, 0, v51
    v_sub_f32 v48, v48, v72
    v_sub_f32 v49, v49, v73
    v_sub_f32 v50, v50, v74
    v_sub_f32 v51, v51, v75
    v_cvt_pk_bf16_f32 v48, 0, v48
    v_cvt_pk_bf16_f32 v49, 0, v49
    v_cvt_pk_bf16_f32 v50, 0, v50
    v_cvt_pk_bf16_f32 v51, 0, v51
    v_mul_f32 v48, v48, v64
    v_mul_f32 v49, v49, v65
    v_mul_f32 v50, v50, v66
    v_mul_f32 v51, v51, v67
    v_cvt_pk_bf16_f32 v48, v48, v48
    v_cvt_pk_bf16_f32 v49, v49, v49
    v_cvt_pk_bf16_f32 v50, v50, v50
    v_cvt_pk_bf16_f32 v51, v51, v51
    s_branch L_join5
L_slow7:
    s_waitcnt lgkmcnt(0)
    s_mov_b32 s59, 64512
    buffer_load_dwordx2 v[52:53], v2, s[28:31], s59 offen
    buffer_load_dwordx2 v[54:55], v2, s[32:35], s59 offen
    buffer_load_dwordx2 v[56:57], v4, s[28:31], s59 offen
    buffer_load_dwordx2 v[58:59], v4, s[32:35], s59 offen
    s_waitcnt vmcnt(0)
    v_lshlrev_b32 v60, 16, v52
    v_and_b32 v61, 0xffff0000, v52
    v_lshlrev_b32 v62, 16, v53
    v_and_b32 v63, 0xffff0000, v53
    v_lshlrev_b32 v68, 16, v54
    v_and_b32 v69, 0xffff0000, v54
    v_lshlrev_b32 v70, 16, v55
    v_and_b32 v71, 0xffff0000, v55
    v_lshlrev_b32 v64, 16, v56
    v_and_b32 v65, 0xffff0000, v56
    v_lshlrev_b32 v66, 16, v57
    v_and_b32 v67, 0xffff0000, v57
    v_lshlrev_b32 v72, 16, v58
    v_and_b32 v73, 0xffff0000, v58
    v_lshlrev_b32 v74, 16, v59
    v_and_b32 v75, 0xffff0000, v59
    v_cvt_f32_i32 v16, v16
    v_cvt_f32_i32 v17, v17
    v_cvt_f32_i32 v18, v18
    v_cvt_f32_i32 v19, v19
    v_cvt_f32_i32 v20, v20
    v_cvt_f32_i32 v21, v21
    v_cvt_f32_i32 v22, v22
    v_cvt_f32_i32 v23, v23
    v_cvt_pk_bf16_f32 v16, 0, v16
    v_cvt_pk_bf16_f32 v17, 0, v17
    v_cvt_pk_bf16_f32 v18, 0, v18
    v_cvt_pk_bf16_f32 v19, 0, v19
    v_cvt_pk_bf16_f32 v20, 0, v20
    v_cvt_pk_bf16_f32 v21, 0, v21
    v_cvt_pk_bf16_f32 v22, 0, v22
    v_cvt_pk_bf16_f32 v23, 0, v23
    v_sub_f32 v16, v16, v68
    v_sub_f32 v17, v17, v69
    v_sub_f32 v18, v18, v70
    v_sub_f32 v19, v19, v71
    v_sub_f32 v20, v20, v68
    v_sub_f32 v21, v21, v69
    v_sub_f32 v22, v22, v70
    v_sub_f32 v23, v23, v71
    v_cvt_pk_bf16_f32 v16, 0, v16
    v_cvt_pk_bf16_f32 v17, 0, v17
    v_cvt_pk_bf16_f32 v18, 0, v18
    v_cvt_pk_bf16_f32 v19, 0, v19
    v_cvt_pk_bf16_f32 v20, 0, v20
    v_cvt_pk_bf16_f32 v21, 0, v21
    v_cvt_pk_bf16_f32 v22, 0, v22
    v_cvt_pk_bf16_f32 v23, 0, v23
    v_mul_f32 v16, v16, v60
    v_mul_f32 v17, v17, v61
    v_mul_f32 v18, v18, v62
    v_mul_f32 v19, v19, v63
    v_mul_f32 v20, v20, v60
    v_mul_f32 v21, v21, v61
    v_mul_f32 v22, v22, v62
    v_mul_f32 v23, v23, v63
    v_cvt_pk_bf16_f32 v76, v16, v20
    v_cvt_pk_bf16_f32 v80, v17, v21
    v_cvt_pk_bf16_f32 v84, v18, v22
    v_cvt_pk_bf16_f32 v88, v19, v23
    v_cvt_f32_i32 v24, v24
    v_cvt_f32_i32 v25, v25
    v_cvt_f32_i32 v26, v26
    v_cvt_f32_i32 v27, v27
    v_cvt_f32_i32 v28, v28
    v_cvt_f32_i32 v29, v29
    v_cvt_f32_i32 v30, v30
    v_cvt_f32_i32 v31, v31
    v_cvt_pk_bf16_f32 v24, 0, v24
    v_cvt_pk_bf16_f32 v25, 0, v25
    v_cvt_pk_bf16_f32 v26, 0, v26
    v_cvt_pk_bf16_f32 v27, 0, v27
    v_cvt_pk_bf16_f32 v28, 0, v28
    v_cvt_pk_bf16_f32 v29, 0, v29
    v_cvt_pk_bf16_f32 v30, 0, v30
    v_cvt_pk_bf16_f32 v31, 0, v31
    v_sub_f32 v24, v24, v68
    v_sub_f32 v25, v25, v69
    v_sub_f32 v26, v26, v70
    v_sub_f32 v27, v27, v71
    v_sub_f32 v28, v28, v68
    v_sub_f32 v29, v29, v69
    v_sub_f32 v30, v30, v70
    v_sub_f32 v31, v31, v71
    v_cvt_pk_bf16_f32 v24, 0, v24
    v_cvt_pk_bf16_f32 v25, 0, v25
    v_cvt_pk_bf16_f32 v26, 0, v26
    v_cvt_pk_bf16_f32 v27, 0, v27
    v_cvt_pk_bf16_f32 v28, 0, v28
    v_cvt_pk_bf16_f32 v29, 0, v29
    v_cvt_pk_bf16_f32 v30, 0, v30
    v_cvt_pk_bf16_f32 v31, 0, v31
    v_mul_f32 v24, v24, v60
    v_mul_f32 v25, v25, v61
    v_mul_f32 v26, v26, v62
    v_mul_f32 v27, v27, v63
    v_mul_f32 v28, v28, v60
    v_mul_f32 v29, v29, v61
    v_mul_f32 v30, v30, v62
    v_mul_f32 v31, v31, v63
    v_cvt_pk_bf16_f32 v77, v24, v28
    v_cvt_pk_bf16_f32 v81, v25, v29
    v_cvt_pk_bf16_f32 v85, v26, v30
    v_cvt_pk_bf16_f32 v89, v27, v31
    v_cvt_f32_i32 v32, v32
    v_cvt_f32_i32 v33, v33
    v_cvt_f32_i32 v34, v34
    v_cvt_f32_i32 v35, v35
    v_cvt_f32_i32 v36, v36
    v_cvt_f32_i32 v37, v37
    v_cvt_f32_i32 v38, v38
    v_cvt_f32_i32 v39, v39
    v_cvt_pk_bf16_f32 v32, 0, v32
    v_cvt_pk_bf16_f32 v33, 0, v33
    v_cvt_pk_bf16_f32 v34, 0, v34
    v_cvt_pk_bf16_f32 v35, 0, v35
    v_cvt_pk_bf16_f32 v36, 0, v36
    v_cvt_pk_bf16_f32 v37, 0, v37
    v_cvt_pk_bf16_f32 v38, 0, v38
    v_cvt_pk_bf16_f32 v39, 0, v39
    v_sub_f32 v32, v32, v68
    v_sub_f32 v33, v33, v69
    v_sub_f32 v34, v34, v70
    v_sub_f32 v35, v35, v71
    v_sub_f32 v36, v36, v68
    v_sub_f32 v37, v37, v69
    v_sub_f32 v38, v38, v70
    v_sub_f32 v39, v39, v71
    v_cvt_pk_bf16_f32 v32, 0, v32
    v_cvt_pk_bf16_f32 v33, 0, v33
    v_cvt_pk_bf16_f32 v34, 0, v34
    v_cvt_pk_bf16_f32 v35, 0, v35
    v_cvt_pk_bf16_f32 v36, 0, v36
    v_cvt_pk_bf16_f32 v37, 0, v37
    v_cvt_pk_bf16_f32 v38, 0, v38
    v_cvt_pk_bf16_f32 v39, 0, v39
    v_mul_f32 v32, v32, v60
    v_mul_f32 v33, v33, v61
    v_mul_f32 v34, v34, v62
    v_mul_f32 v35, v35, v63
    v_mul_f32 v36, v36, v60
    v_mul_f32 v37, v37, v61
    v_mul_f32 v38, v38, v62
    v_mul_f32 v39, v39, v63
    v_cvt_pk_bf16_f32 v78, v32, v36
    v_cvt_pk_bf16_f32 v82, v33, v37
    v_cvt_pk_bf16_f32 v86, v34, v38
    v_cvt_pk_bf16_f32 v90, v35, v39
    v_cvt_f32_i32 v40, v40
    v_cvt_f32_i32 v41, v41
    v_cvt_f32_i32 v42, v42
    v_cvt_f32_i32 v43, v43
    v_cvt_f32_i32 v44, v44
    v_cvt_f32_i32 v45, v45
    v_cvt_f32_i32 v46, v46
    v_cvt_f32_i32 v47, v47
    v_cvt_pk_bf16_f32 v40, 0, v40
    v_cvt_pk_bf16_f32 v41, 0, v41
    v_cvt_pk_bf16_f32 v42, 0, v42
    v_cvt_pk_bf16_f32 v43, 0, v43
    v_cvt_pk_bf16_f32 v44, 0, v44
    v_cvt_pk_bf16_f32 v45, 0, v45
    v_cvt_pk_bf16_f32 v46, 0, v46
    v_cvt_pk_bf16_f32 v47, 0, v47
    v_sub_f32 v40, v40, v68
    v_sub_f32 v41, v41, v69
    v_sub_f32 v42, v42, v70
    v_sub_f32 v43, v43, v71
    v_sub_f32 v44, v44, v68
    v_sub_f32 v45, v45, v69
    v_sub_f32 v46, v46, v70
    v_sub_f32 v47, v47, v71
    v_cvt_pk_bf16_f32 v40, 0, v40
    v_cvt_pk_bf16_f32 v41, 0, v41
    v_cvt_pk_bf16_f32 v42, 0, v42
    v_cvt_pk_bf16_f32 v43, 0, v43
    v_cvt_pk_bf16_f32 v44, 0, v44
    v_cvt_pk_bf16_f32 v45, 0, v45
    v_cvt_pk_bf16_f32 v46, 0, v46
    v_cvt_pk_bf16_f32 v47, 0, v47
    v_mul_f32 v40, v40, v60
    v_mul_f32 v41, v41, v61
    v_mul_f32 v42, v42, v62
    v_mul_f32 v43, v43, v63
    v_mul_f32 v44, v44, v60
    v_mul_f32 v45, v45, v61
    v_mul_f32 v46, v46, v62
    v_mul_f32 v47, v47, v63
    v_cvt_pk_bf16_f32 v79, v40, v44
    v_cvt_pk_bf16_f32 v83, v41, v45
    v_cvt_pk_bf16_f32 v87, v42, v46
    v_cvt_pk_bf16_f32 v91, v43, v47
    v_cvt_f32_i32 v48, v48
    v_cvt_f32_i32 v49, v49
    v_cvt_f32_i32 v50, v50
    v_cvt_f32_i32 v51, v51
    v_cvt_pk_bf16_f32 v48, 0, v48
    v_cvt_pk_bf16_f32 v49, 0, v49
    v_cvt_pk_bf16_f32 v50, 0, v50
    v_cvt_pk_bf16_f32 v51, 0, v51
    v_sub_f32 v48, v48, v72
    v_sub_f32 v49, v49, v73
    v_sub_f32 v50, v50, v74
    v_sub_f32 v51, v51, v75
    v_cvt_pk_bf16_f32 v48, 0, v48
    v_cvt_pk_bf16_f32 v49, 0, v49
    v_cvt_pk_bf16_f32 v50, 0, v50
    v_cvt_pk_bf16_f32 v51, 0, v51
    v_mul_f32 v48, v48, v64
    v_mul_f32 v49, v49, v65
    v_mul_f32 v50, v50, v66
    v_mul_f32 v51, v51, v67
    v_cvt_pk_bf16_f32 v48, v48, v48
    v_cvt_pk_bf16_f32 v49, v49, v49
    v_cvt_pk_bf16_f32 v50, v50, v50
    v_cvt_pk_bf16_f32 v51, v51, v51
    s_branch L_join7
.section .rodata,"a"
.p2align 6
.amdhsa_kernel standalone__weight_only_int_quip_2__prompt_kernel
  .amdhsa_next_free_vgpr 128
  .amdhsa_next_free_sgpr 96
  .amdhsa_accum_offset 128
  .amdhsa_group_segment_fixed_size 0
  .amdhsa_kernarg_size 56
  .amdhsa_user_sgpr_count 2
  .amdhsa_user_sgpr_kernarg_segment_ptr 1
  .amdhsa_system_sgpr_workgroup_id_x 1
  .amdhsa_float_denorm_mode_32 3
.end_amdhsa_kernel
```
